```python
import torch

def _softmax(x, axis=-1):
    return torch.softmax(x, dim=axis)
def _gelu(x):
    return torch.nn.functional.gelu(x, approximate="tanh")
def _silu(x):
    return torch.nn.functional.silu(x)
def _sigmoid(x):
    return torch.sigmoid(x)
def _layernorm(x, axis=-1, eps=1e-5):
    m = x.mean(dim=axis, keepdim=True)
    v = x.var(dim=axis, keepdim=True, unbiased=False)
    return (x - m) / torch.sqrt(v + eps)
def _scatter_add(tgt, idx, src, axis=0):
    return tgt.clone().index_add_(axis, idx, src)
def _segment_sum(src, seg, n):
    out = torch.zeros((n,) + src.shape[1:], dtype=src.dtype)
    return out.index_add_(0, seg, src)
def _pad(x, pw):
    flat = tuple(v for pair in reversed(pw) for v in pair)
    return torch.nn.functional.pad(x, flat)

kernel_name = 'standalone__mixer_channel_mlp__prompt'

def setup_inputs():

    _w = (lambda a: (lambda t: t.to(torch.bfloat16) if t.is_floating_point() else t)(torch.as_tensor(a)))
    B, S, D, F = 1, 2048, 640, 1536
    return {
        "x": _w((lambda *s: torch.randn(*s, dtype=torch.bfloat16) * 0.05)(B, S, D)),
        "w1": _w((lambda *s: torch.randn(*s, dtype=torch.bfloat16) * 0.8)(D, F) * (D ** -0.5)),
        "b1": _w((lambda *s: torch.randn(*s, dtype=torch.bfloat16) * 0.4)(F)),
        "w2": _w((lambda *s: torch.randn(*s, dtype=torch.bfloat16) * 0.05)(F, D) * (F ** -0.5)),
        "b2": _w((lambda *s: torch.randn(*s, dtype=torch.bfloat16) * 0.05)(D)),
    }

def reference(x, w1, b1, w2, b2):
    y = _layernorm(x, axis=-1)
    h = _gelu(torch.einsum("bsd,df->bsf", y, w1) + b1)
    return torch.einsum("bsf,fd->bsd", h, w2) + b2
```

```asm
; @launch grid=(256,1,1) block=(512,1,1) lds=163840
.amdgcn_target "amdgcn-amd-amdhsa--gfx950"
.text
.globl standalone__mixer_channel_mlp__prompt_kernel
.p2align 8
.type standalone__mixer_channel_mlp__prompt_kernel,@function
standalone__mixer_channel_mlp__prompt_kernel:
    s_cmp_ge_u32 s2, 256
    s_cbranch_scc1 L_end
    s_load_dwordx16 s[76:91], s[0:1], 0
    v_and_b32 v1, 63, v0
    v_lshrrev_b32 v12, 6, v0
    v_lshlrev_b32 v2, 4, v1
    v_readfirstlane_b32 s36, v12
    s_and_b32 s46, s2, 7
    s_lshr_b32 s59, s2, 3
    s_lshr_b32 s47, s46, 1
    s_and_b32 s48, s46, 1
    s_lshr_b32 s44, s59, 3
    s_lshl_b32 s38, s47, 2
    s_add_u32 s38, s38, s44
    s_and_b32 s46, s59, 7
    s_lshl_b32 s39, s48, 3
    s_add_u32 s39, s39, s46
    s_mul_i32 s44, s44, 3
    s_add_u32 s44, s44, s46
    s_cmp_ge_u32 s44, 10
    s_cselect_b32 s46, 10, 0
    s_sub_u32 s44, s44, s46
    s_and_b32 s44, s44, 1
    s_mul_i32 s44, s44, 5
    s_lshl_b32 s40, s38, 4
    s_add_u32 s40, s40, s39
    s_lshr_b32 s43, s59, 2
    s_lshl_b32 s41, s47, 3
    s_add_u32 s41, s41, s43
    s_and_b32 s42, s59, 3
    s_lshl_b32 s48, s48, 2
    s_add_u32 s42, s42, s48
    s_and_b32 s37, s36, 3
    v_lshrrev_b32 v3, 5, v1
    v_and_b32 v4, 31, v1
    v_mov_b32 v5, 0
    s_mul_i32 s56, s37, 20480
    s_add_u32 s56, s56, 73728
    s_mul_i32 s60, s39, 192
    s_cmp_lt_u32 s36, 4
    s_cbranch_scc1 L_cpath
    v_lshrrev_b32 v18, 4, v1
    v_bfe_u32 v19, v1, 3, 1
    v_and_b32 v20, 7, v1
    v_add_u32 v21, 0, v18
    v_xor_b32 v22, v20, v21
    v_lshl_add_u32 v21, v19, 3, v21
    v_mul_u32_u24 v21, 1280, v21
    v_lshl_add_u32 v32, v22, 4, v21
    v_add_u32 v34, 20480, v32
    v_add_u32 v21, 4, v18
    v_xor_b32 v22, v20, v21
    v_lshl_add_u32 v21, v19, 3, v21
    v_mul_u32_u24 v21, 1280, v21
    v_lshl_add_u32 v33, v22, 4, v21
    v_add_u32 v35, 20480, v33
    s_lshl_b32 s57, s38, 2
    s_add_u32 s57, s57, s37
    s_mul_i32 s57, s57, 40960
    s_mul_i32 s67, s37, 3072
    v_add_u32 v18, 0, v1
    v_mul_u32_u24 v19, 5462, v18
    v_lshrrev_b32 v19, 16, v19
    v_mul_u32_u24 v20, 12, v19
    v_sub_u32 v20, v18, v20
    v_mul_u32_u24 v19, 3072, v19
    v_lshl_add_u32 v36, v20, 4, v19
    v_add_u32 v18, 64, v1
    v_mul_u32_u24 v19, 5462, v18
    v_lshrrev_b32 v19, 16, v19
    v_mul_u32_u24 v20, 12, v19
    v_sub_u32 v20, v18, v20
    v_mul_u32_u24 v19, 3072, v19
    v_lshl_add_u32 v37, v20, 4, v19
    v_add_u32 v18, 128, v1
    v_mul_u32_u24 v19, 5462, v18
    v_lshrrev_b32 v19, 16, v19
    v_mul_u32_u24 v20, 12, v19
    v_sub_u32 v20, v18, v20
    v_mul_u32_u24 v19, 3072, v19
    v_lshl_add_u32 v38, v20, 4, v19
    s_mul_i32 s46, s37, 49152
    s_add_u32 s68, s60, s46
    s_waitcnt lgkmcnt(0)
    s_mov_b32 s4, s76
    s_mov_b32 s5, s77
    s_mov_b32 s6, 2621440
    s_mov_b32 s7, 0x00020000
    s_mov_b32 s8, s78
    s_mov_b32 s9, s79
    s_mov_b32 s10, 1966080
    s_mov_b32 s11, 0x00020000
    s_lshl_b32 s65, s44, 7
    s_add_u32 s65, s65, s57
    s_mul_i32 s66, s44, 196608
    s_add_u32 s66, s66, s68
    s_add_u32 m0, s56, 0
    s_add_u32 s44, s44, 1
    buffer_load_dwordx4 v32, s[4:7], s65 offen lds
    s_add_u32 m0, s67, 0
    s_cmp_eq_u32 s44, 10
    s_cselect_b32 s44, 0, s44
    buffer_load_dwordx4 v36, s[8:11], s66 offen lds
    s_add_u32 m0, s56, 1024
    s_nop 0
    buffer_load_dwordx4 v33, s[4:7], s65 offen lds
    s_add_u32 m0, s67, 1024
    s_nop 0
    buffer_load_dwordx4 v37, s[8:11], s66 offen lds
    s_add_u32 m0, s56, 2048
    s_nop 0
    buffer_load_dwordx4 v34, s[4:7], s65 offen lds
    s_add_u32 m0, s67, 2048
    s_nop 0
    buffer_load_dwordx4 v38, s[8:11], s66 offen lds
    s_add_u32 m0, s56, 3072
    s_nop 0
    buffer_load_dwordx4 v35, s[4:7], s65 offen lds
    s_lshl_b32 s65, s44, 7
    s_add_u32 s65, s65, s57
    s_mul_i32 s66, s44, 196608
    s_add_u32 s66, s66, s68
    s_add_u32 m0, s56, 4096
    s_add_u32 s44, s44, 1
    buffer_load_dwordx4 v32, s[4:7], s65 offen lds
    s_add_u32 m0, s67, 12288
    s_cmp_eq_u32 s44, 10
    s_cselect_b32 s44, 0, s44
    buffer_load_dwordx4 v36, s[8:11], s66 offen lds
    s_add_u32 m0, s56, 5120
    s_nop 0
    buffer_load_dwordx4 v33, s[4:7], s65 offen lds
    s_add_u32 m0, s67, 13312
    s_nop 0
    buffer_load_dwordx4 v37, s[8:11], s66 offen lds
    s_add_u32 m0, s56, 6144
    s_nop 0
    buffer_load_dwordx4 v34, s[4:7], s65 offen lds
    s_add_u32 m0, s67, 14336
    s_nop 0
    buffer_load_dwordx4 v38, s[8:11], s66 offen lds
    s_add_u32 m0, s56, 7168
    s_nop 0
    buffer_load_dwordx4 v35, s[4:7], s65 offen lds
    s_waitcnt vmcnt(7)
    s_barrier
    s_lshl_b32 s65, s44, 7
    s_add_u32 s65, s65, s57
    s_mul_i32 s66, s44, 196608
    s_add_u32 s66, s66, s68
    s_add_u32 m0, s56, 8192
    s_add_u32 s44, s44, 1
    buffer_load_dwordx4 v32, s[4:7], s65 offen lds
    s_add_u32 m0, s67, 24576
    s_cmp_eq_u32 s44, 10
    s_cselect_b32 s44, 0, s44
    buffer_load_dwordx4 v36, s[8:11], s66 offen lds
    s_add_u32 m0, s56, 9216
    s_nop 0
    buffer_load_dwordx4 v33, s[4:7], s65 offen lds
    s_add_u32 m0, s67, 25600
    s_nop 0
    buffer_load_dwordx4 v37, s[8:11], s66 offen lds
    s_add_u32 m0, s56, 10240
    s_nop 0
    buffer_load_dwordx4 v34, s[4:7], s65 offen lds
    s_add_u32 m0, s67, 26624
    s_nop 0
    buffer_load_dwordx4 v38, s[8:11], s66 offen lds
    s_add_u32 m0, s56, 11264
    s_nop 0
    buffer_load_dwordx4 v35, s[4:7], s65 offen lds
    s_mov_b32 s16, s82
    s_mov_b32 s17, s83
    s_mov_b32 s18, 1966080
    s_mov_b32 s19, 0x00020000
    s_mov_b32 s28, s88
    s_mov_b32 s29, s89
    s_mov_b32 s30, 256
    s_mov_b32 s31, 0x00020000
    s_mov_b32 s32, s90
    s_mov_b32 s33, s91
    s_mov_b32 s34, 18874368
    s_mov_b32 s35, 0x00020000
    s_mov_b32 s12, s80
    s_mov_b32 s13, s81
    s_mov_b32 s14, 3072
    s_mov_b32 s15, 0x00020000
    s_mov_b32 s20, s84
    s_mov_b32 s21, s85
    s_mov_b32 s22, 1280
    s_mov_b32 s23, 0x00020000
    s_mov_b32 s24, s86
    s_mov_b32 s25, s87
    s_mov_b32 s26, 2621440
    s_mov_b32 s27, 0x00020000
    s_waitcnt vmcnt(7)
    s_barrier
    s_lshl_b32 s65, s44, 7
    s_add_u32 s65, s65, s57
    s_mul_i32 s66, s44, 196608
    s_add_u32 s66, s66, s68
    s_add_u32 m0, s56, 12288
    s_add_u32 s44, s44, 1
    buffer_load_dwordx4 v32, s[4:7], s65 offen lds
    s_add_u32 m0, s67, 36864
    s_cmp_eq_u32 s44, 10
    s_cselect_b32 s44, 0, s44
    buffer_load_dwordx4 v36, s[8:11], s66 offen lds
    s_add_u32 m0, s56, 13312
    s_nop 0
    buffer_load_dwordx4 v33, s[4:7], s65 offen lds
    s_add_u32 m0, s67, 37888
    s_nop 0
    buffer_load_dwordx4 v37, s[8:11], s66 offen lds
    s_add_u32 m0, s56, 14336
    s_nop 0
    buffer_load_dwordx4 v34, s[4:7], s65 offen lds
    s_add_u32 m0, s67, 38912
    s_nop 0
    buffer_load_dwordx4 v38, s[8:11], s66 offen lds
    s_add_u32 m0, s56, 15360
    s_nop 0
    buffer_load_dwordx4 v35, s[4:7], s65 offen lds
    s_lshl_b32 s46, s40, 7
    s_lshl_b32 s47, s36, 2
    s_add_u32 s46, s46, s47
    s_add_u32 s46, s46, 12582976
    v_mov_b32 v6, s46
    s_mul_i32 s49, s43, 3
    s_lshr_b32 s49, s49, 2
    s_mul_i32 s88, s36, 6
    s_mul_i32 s89, s42, 48
    s_add_u32 s89, s89, s88
    s_add_u32 s46, s49, s88
    s_lshl_b32 s82, s46, 10
    s_add_u32 s46, s49, s89
    s_mul_i32 s76, s46, 5120
    s_add_u32 s49, s49, 1
    s_cmp_eq_u32 s49, 6
    s_cselect_b32 s49, 0, s49
    s_add_u32 s46, s49, s88
    s_lshl_b32 s83, s46, 10
    s_add_u32 s46, s49, s89
    s_mul_i32 s77, s46, 5120
    s_add_u32 s49, s49, 1
    s_cmp_eq_u32 s49, 6
    s_cselect_b32 s49, 0, s49
    s_add_u32 s46, s49, s88
    s_lshl_b32 s84, s46, 10
    s_add_u32 s46, s49, s89
    s_mul_i32 s78, s46, 5120
    s_add_u32 s49, s49, 1
    s_cmp_eq_u32 s49, 6
    s_cselect_b32 s49, 0, s49
    s_add_u32 s46, s49, s88
    s_lshl_b32 s85, s46, 10
    s_add_u32 s46, s49, s89
    s_mul_i32 s79, s46, 5120
    s_add_u32 s49, s49, 1
    s_cmp_eq_u32 s49, 6
    s_cselect_b32 s49, 0, s49
    s_add_u32 s46, s49, s88
    s_lshl_b32 s86, s46, 10
    s_add_u32 s46, s49, s89
    s_mul_i32 s80, s46, 5120
    s_add_u32 s49, s49, 1
    s_cmp_eq_u32 s49, 6
    s_cselect_b32 s49, 0, s49
    s_add_u32 s46, s49, s88
    s_lshl_b32 s87, s46, 10
    s_add_u32 s46, s49, s89
    s_mul_i32 s81, s46, 5120
    s_add_u32 s49, s49, 1
    s_cmp_eq_u32 s49, 6
    s_cselect_b32 s49, 0, s49
    s_add_u32 s46, s36, 1
    s_and_b32 s46, s46, 3
    s_lshl_b32 s47, s41, 2
    s_add_u32 s46, s46, s47
    s_mul_i32 s46, s46, 49152
    s_add_u32 s52, s46, 4194304
    s_add_u32 s46, s36, 2
    s_and_b32 s46, s46, 3
    s_lshl_b32 s47, s41, 2
    s_add_u32 s46, s46, s47
    s_mul_i32 s46, s46, 49152
    s_add_u32 s53, s46, 4194304
    s_add_u32 s46, s36, 3
    s_and_b32 s46, s46, 3
    s_lshl_b32 s47, s41, 2
    s_add_u32 s46, s46, s47
    s_mul_i32 s46, s46, 49152
    s_add_u32 s54, s46, 4194304
    s_add_u32 s46, s36, 4
    s_and_b32 s46, s46, 3
    s_lshl_b32 s47, s41, 2
    s_add_u32 s46, s46, s47
    s_mul_i32 s46, s46, 49152
    s_add_u32 s55, s46, 4194304
    v_cmp_le_u32 vcc, 6, v1
    s_mul_i32 s46, s42, 5
    s_nop 0
    v_cndmask_b32 v19, 0, 1, vcc
    v_lshl_add_u32 v18, v19, 2, s46
    v_lshrrev_b32 v18, 3, v18
    v_mul_u32_u24 v18, 48, v18
    v_mul_u32_u24 v19, 6, v19
    v_sub_u32 v19, v1, v19
    v_add3_u32 v18, v18, v19, s88
    v_cmp_gt_u32 vcc, 12, v1
    v_readfirstlane_b32 s46, v18
    s_nop 1
    v_mov_b32 v19, s46
    v_cndmask_b32 v39, v19, v18, vcc
    v_lshlrev_b32 v39, 7, v39
    v_add_u32 v39, 12582976, v39
    s_lshl_b32 s46, s38, 4
    s_lshl_b32 s47, s36, 1
    s_add_u32 s46, s46, s47
    v_and_b32 v19, 1, v1
    v_add_u32 v19, s46, v19
    s_and_b32 s47, s41, 1
    s_lshl_b32 s47, s47, 3
    s_add_u32 s47, s47, 12582976
    v_lshlrev_b32 v7, 7, v19
    v_add_u32 v7, s47, v7
    s_waitcnt vmcnt(7)
    s_barrier
    s_lshl_b32 s65, s44, 7
    s_add_u32 s65, s65, s57
    s_mul_i32 s66, s44, 196608
    s_add_u32 s66, s66, s68
    s_add_u32 m0, s56, 16384
    s_add_u32 s44, s44, 1
    buffer_load_dwordx4 v32, s[4:7], s65 offen lds
    s_add_u32 m0, s67, 49152
    s_cmp_eq_u32 s44, 10
    s_cselect_b32 s44, 0, s44
    buffer_load_dwordx4 v36, s[8:11], s66 offen lds
    s_add_u32 m0, s56, 17408
    s_nop 0
    buffer_load_dwordx4 v33, s[4:7], s65 offen lds
    s_add_u32 m0, s67, 50176
    s_nop 0
    buffer_load_dwordx4 v37, s[8:11], s66 offen lds
    s_add_u32 m0, s56, 18432
    s_nop 0
    buffer_load_dwordx4 v34, s[4:7], s65 offen lds
    s_add_u32 m0, s67, 51200
    s_nop 0
    buffer_load_dwordx4 v38, s[8:11], s66 offen lds
    s_add_u32 m0, s56, 19456
    s_nop 0
    buffer_load_dwordx4 v35, s[4:7], s65 offen lds
    s_sub_u32 s46, s43, s36
    s_mul_i32 s46, s46, 768
    v_add_u32 v43, s46, v39
    s_mul_i32 s46, s42, 48
    s_mul_i32 s47, s43, 6
    s_add_u32 s46, s46, s47
    s_mul_i32 s46, s46, 5120
    s_mul_i32 s47, s37, 7680
    s_add_u32 s69, s46, s47
    buffer_load_dword v8, v5, s[28:31], 0 offen sc1
    s_waitcnt vmcnt(8)
    s_barrier
    s_lshl_b32 s65, s44, 7
    s_add_u32 s65, s65, s57
    s_mul_i32 s66, s44, 196608
    s_add_u32 s66, s66, s68
    s_add_u32 m0, s56, 0
    s_add_u32 s44, s44, 1
    buffer_load_dwordx4 v32, s[4:7], s65 offen lds
    s_add_u32 m0, s67, 61440
    s_cmp_eq_u32 s44, 10
    s_cselect_b32 s44, 0, s44
    buffer_load_dwordx4 v36, s[8:11], s66 offen lds
    s_add_u32 m0, s56, 1024
    s_nop 0
    buffer_load_dwordx4 v33, s[4:7], s65 offen lds
    s_add_u32 m0, s67, 62464
    s_nop 0
    buffer_load_dwordx4 v37, s[8:11], s66 offen lds
    s_add_u32 m0, s56, 2048
    s_nop 0
    buffer_load_dwordx4 v34, s[4:7], s65 offen lds
    s_add_u32 m0, s67, 63488
    s_nop 0
    buffer_load_dwordx4 v38, s[8:11], s66 offen lds
    s_add_u32 m0, s56, 3072
    s_nop 0
    buffer_load_dwordx4 v35, s[4:7], s65 offen lds
    s_waitcnt vmcnt(7)
    v_readfirstlane_b32 s45, v8
    s_nop 3
    s_cmp_lg_u32 s45, 0
    s_cbranch_scc1 L_ok1
    s_mov_b32 s49, 60000
L_retry2:
    s_sub_u32 s49, s49, 1
    s_cmp_eq_u32 s49, 0
    s_cbranch_scc1 L_ok1
    buffer_load_dword v8, v5, s[28:31], 0 offen sc1
    s_waitcnt vmcnt(0)
    v_readfirstlane_b32 s45, v8
    s_nop 3
    s_cmp_lg_u32 s45, 0
    s_cbranch_scc0 L_retry2
L_ok1:
    s_barrier
    s_lshl_b32 s65, s44, 7
    s_add_u32 s65, s65, s57
    s_mul_i32 s66, s44, 196608
    s_add_u32 s66, s66, s68
    s_add_u32 m0, s56, 4096
    s_add_u32 s44, s44, 1
    buffer_load_dwordx4 v32, s[4:7], s65 offen lds
    s_add_u32 m0, s67, 0
    s_cmp_eq_u32 s44, 10
    s_cselect_b32 s44, 0, s44
    buffer_load_dwordx4 v36, s[8:11], s66 offen lds
    s_add_u32 m0, s56, 5120
    s_nop 0
    buffer_load_dwordx4 v33, s[4:7], s65 offen lds
    s_add_u32 m0, s67, 1024
    s_nop 0
    buffer_load_dwordx4 v37, s[8:11], s66 offen lds
    s_add_u32 m0, s56, 6144
    s_nop 0
    buffer_load_dwordx4 v34, s[4:7], s65 offen lds
    s_add_u32 m0, s67, 2048
    s_nop 0
    buffer_load_dwordx4 v38, s[8:11], s66 offen lds
    s_add_u32 m0, s56, 7168
    s_nop 0
    buffer_load_dwordx4 v35, s[4:7], s65 offen lds
    s_waitcnt vmcnt(7)
    s_barrier
    s_lshl_b32 s65, s44, 7
    s_add_u32 s65, s65, s57
    s_mul_i32 s66, s44, 196608
    s_add_u32 s66, s66, s68
    s_add_u32 m0, s56, 8192
    s_add_u32 s44, s44, 1
    buffer_load_dwordx4 v32, s[4:7], s65 offen lds
    s_add_u32 m0, s67, 12288
    s_cmp_eq_u32 s44, 10
    s_cselect_b32 s44, 0, s44
    buffer_load_dwordx4 v36, s[8:11], s66 offen lds
    s_add_u32 m0, s56, 9216
    s_nop 0
    buffer_load_dwordx4 v33, s[4:7], s65 offen lds
    s_add_u32 m0, s67, 13312
    s_nop 0
    buffer_load_dwordx4 v37, s[8:11], s66 offen lds
    s_add_u32 m0, s56, 10240
    s_nop 0
    buffer_load_dwordx4 v34, s[4:7], s65 offen lds
    s_add_u32 m0, s67, 14336
    s_nop 0
    buffer_load_dwordx4 v38, s[8:11], s66 offen lds
    s_add_u32 m0, s56, 11264
    s_nop 0
    buffer_load_dwordx4 v35, s[4:7], s65 offen lds
    s_waitcnt vmcnt(7)
    s_barrier
    s_lshl_b32 s65, s44, 7
    s_add_u32 s65, s65, s57
    s_mul_i32 s66, s44, 196608
    s_add_u32 s66, s66, s68
    s_add_u32 m0, s56, 12288
    s_add_u32 s44, s44, 1
    buffer_load_dwordx4 v32, s[4:7], s65 offen lds
    s_add_u32 m0, s67, 24576
    s_cmp_eq_u32 s44, 10
    s_cselect_b32 s44, 0, s44
    buffer_load_dwordx4 v36, s[8:11], s66 offen lds
    s_add_u32 m0, s56, 13312
    s_nop 0
    buffer_load_dwordx4 v33, s[4:7], s65 offen lds
    s_add_u32 m0, s67, 25600
    s_nop 0
    buffer_load_dwordx4 v37, s[8:11], s66 offen lds
    s_add_u32 m0, s56, 14336
    s_nop 0
    buffer_load_dwordx4 v34, s[4:7], s65 offen lds
    s_add_u32 m0, s67, 26624
    s_nop 0
    buffer_load_dwordx4 v38, s[8:11], s66 offen lds
    s_add_u32 m0, s56, 15360
    s_nop 0
    buffer_load_dwordx4 v35, s[4:7], s65 offen lds
    s_waitcnt vmcnt(7)
    s_barrier
    s_lshl_b32 s65, s44, 7
    s_add_u32 s65, s65, s57
    s_mul_i32 s66, s44, 196608
    s_add_u32 s66, s66, s68
    s_add_u32 m0, s56, 16384
    s_add_u32 s44, s44, 1
    buffer_load_dwordx4 v32, s[4:7], s65 offen lds
    s_add_u32 m0, s67, 36864
    s_cmp_eq_u32 s44, 10
    s_cselect_b32 s44, 0, s44
    buffer_load_dwordx4 v36, s[8:11], s66 offen lds
    s_add_u32 m0, s56, 17408
    s_nop 0
    buffer_load_dwordx4 v33, s[4:7], s65 offen lds
    s_add_u32 m0, s67, 37888
    s_nop 0
    buffer_load_dwordx4 v37, s[8:11], s66 offen lds
    s_add_u32 m0, s56, 18432
    s_nop 0
    buffer_load_dwordx4 v34, s[4:7], s65 offen lds
    s_add_u32 m0, s67, 38912
    s_nop 0
    buffer_load_dwordx4 v38, s[8:11], s66 offen lds
    s_add_u32 m0, s56, 19456
    s_nop 0
    buffer_load_dwordx4 v35, s[4:7], s65 offen lds
    buffer_load_dwordx2 v[8:9], v39, s[32:35], 0 offen sc1
    s_waitcnt vmcnt(8)
    s_barrier
    s_waitcnt vmcnt(0)
    s_or_b32 s46, s45, 1
    v_xor_b32 v8, s46, v8
    v_xor_b32 v9, s46, v9
    v_or_b32 v8, v8, v9
    v_and_b32 v8, 0xfffffffd, v8
    v_cmp_eq_u32 vcc, 0, v8
    s_nop 1
    s_cmp_eq_u64 vcc, -1
    s_cbranch_scc1 L_ok3
    s_mov_b32 s49, 60000
L_retry4:
    s_sub_u32 s49, s49, 1
    s_cmp_eq_u32 s49, 0
    s_cbranch_scc1 L_ok3
    buffer_load_dwordx2 v[8:9], v39, s[32:35], 0 offen sc1
    s_waitcnt vmcnt(0)
    s_or_b32 s46, s45, 1
    v_xor_b32 v8, s46, v8
    v_xor_b32 v9, s46, v9
    v_or_b32 v8, v8, v9
    v_and_b32 v8, 0xfffffffd, v8
    v_cmp_eq_u32 vcc, 0, v8
    s_nop 1
    s_cmp_eq_u64 vcc, -1
    s_cbranch_scc0 L_retry4
L_ok3:
    buffer_load_dwordx4 a[0:3], v2, s[32:35], s76 offen offset:0 sc1
    buffer_load_dwordx4 a[4:7], v2, s[32:35], s76 offen offset:1024 sc1
    buffer_load_dwordx4 a[8:11], v2, s[32:35], s76 offen offset:2048 sc1
    buffer_load_dwordx4 a[12:15], v2, s[32:35], s76 offen offset:3072 sc1
    s_add_u32 s46, s76, 4096
    buffer_load_dwordx4 a[16:19], v2, s[32:35], s46 offen offset:0 sc1
    s_barrier
    buffer_load_dwordx4 a[20:23], v2, s[32:35], s77 offen offset:0 sc1
    buffer_load_dwordx4 a[24:27], v2, s[32:35], s77 offen offset:1024 sc1
    buffer_load_dwordx4 a[28:31], v2, s[32:35], s77 offen offset:2048 sc1
    buffer_load_dwordx4 a[32:35], v2, s[32:35], s77 offen offset:3072 sc1
    s_add_u32 s46, s77, 4096
    buffer_load_dwordx4 a[36:39], v2, s[32:35], s46 offen offset:0 sc1
    s_barrier
    buffer_load_dwordx4 a[40:43], v2, s[32:35], s78 offen offset:0 sc1
    buffer_load_dwordx4 a[44:47], v2, s[32:35], s78 offen offset:1024 sc1
    buffer_load_dwordx4 a[48:51], v2, s[32:35], s78 offen offset:2048 sc1
    buffer_load_dwordx4 a[52:55], v2, s[32:35], s78 offen offset:3072 sc1
    s_add_u32 s46, s78, 4096
    buffer_load_dwordx4 a[56:59], v2, s[32:35], s46 offen offset:0 sc1
    buffer_load_dwordx4 a[60:63], v2, s[32:35], s79 offen offset:0 sc1
    buffer_load_dwordx4 a[64:67], v2, s[32:35], s79 offen offset:1024 sc1
    buffer_load_dwordx4 a[68:71], v2, s[32:35], s79 offen offset:2048 sc1
    buffer_load_dwordx4 a[72:75], v2, s[32:35], s79 offen offset:3072 sc1
    s_add_u32 s46, s79, 4096
    buffer_load_dwordx4 a[76:79], v2, s[32:35], s46 offen offset:0 sc1
    buffer_load_dwordx4 a[80:83], v2, s[32:35], s80 offen offset:0 sc1
    buffer_load_dwordx4 a[84:87], v2, s[32:35], s80 offen offset:1024 sc1
    buffer_load_dwordx4 a[88:91], v2, s[32:35], s80 offen offset:2048 sc1
    buffer_load_dwordx4 a[92:95], v2, s[32:35], s80 offen offset:3072 sc1
    s_add_u32 s46, s80, 4096
    buffer_load_dwordx4 a[96:99], v2, s[32:35], s46 offen offset:0 sc1
    buffer_load_dwordx4 a[100:103], v2, s[32:35], s81 offen offset:0 sc1
    buffer_load_dwordx4 a[104:107], v2, s[32:35], s81 offen offset:1024 sc1
    buffer_load_dwordx4 a[108:111], v2, s[32:35], s81 offen offset:2048 sc1
    buffer_load_dwordx4 a[112:115], v2, s[32:35], s81 offen offset:3072 sc1
    s_add_u32 s46, s81, 4096
    buffer_load_dwordx4 a[116:119], v2, s[32:35], s46 offen offset:0 sc1
    s_barrier
    s_branch L_join
L_cpath:
    v_mul_u32_u24 v54, 1280, v3
    v_lshl_add_u32 v54, v4, 3, v54
    s_lshl_b32 s46, s40, 3
    s_lshl_b32 s47, s37, 1
    s_add_u32 s46, s46, s47
    s_mul_i32 s74, s46, 1280
    s_mul_i32 s61, s40, 1366
    s_lshr_b32 s61, s61, 16
    s_mul_i32 s48, s61, 48
    s_sub_u32 s62, s40, s48
    v_lshrrev_b32 v55, 3, v1
    v_mul_u32_u24 v55, 1280, v55
    v_and_b32 v18, 7, v1
    v_lshl_add_u32 v55, v18, 4, v55
    s_mul_i32 s75, s62, 40960
    s_lshl_b32 s47, s61, 8
    s_add_u32 s75, s75, s47
    s_lshl_b32 s47, s37, 7
    s_add_u32 s75, s75, s47
    s_cmp_ge_u32 s40, 240
    s_cselect_b32 s71, 1, 0
    s_lshr_b32 s46, s37, 1
    s_or_b32 s71, s71, s46
    s_waitcnt lgkmcnt(0)
    s_mov_b32 s4, s76
    s_mov_b32 s5, s77
    s_mov_b32 s6, 2621440
    s_mov_b32 s7, 0x00020000
    s_mov_b32 s16, s82
    s_mov_b32 s17, s83
    s_mov_b32 s18, 1966080
    s_mov_b32 s19, 0x00020000
    s_mov_b32 s28, s88
    s_mov_b32 s29, s89
    s_mov_b32 s30, 256
    s_mov_b32 s31, 0x00020000
    s_or_b32 s46, s2, s37
    s_cmp_lg_u32 s46, 0
    s_cbranch_scc1 L_nononce5
    s_memrealtime s[50:51]
    s_waitcnt lgkmcnt(0)
    s_lshl_b32 s46, s50, 2
    s_or_b32 s46, s46, 0x80000000
    v_mov_b32 v16, s46
    s_mov_b64 exec, 1
    buffer_store_dword v16, v5, s[28:31], 0 offen sc1
    s_mov_b64 exec, -1
L_nononce5:
    s_cmp_lg_u32 s71, 0
    s_cbranch_scc1 L_nopiece6
    s_lshl_b32 s47, s37, 12
    s_add_u32 m0, s47, 155648
    s_nop 0
    buffer_load_dwordx4 v55, s[16:19], s75 offen nt lds
    s_add_u32 m0, m0, 1024
    s_add_u32 s75, s75, 10240
    buffer_load_dwordx4 v55, s[16:19], s75 offen nt lds
    s_add_u32 m0, m0, 1024
    s_add_u32 s75, s75, 10240
    buffer_load_dwordx4 v55, s[16:19], s75 offen nt lds
    s_add_u32 m0, m0, 1024
    s_add_u32 s75, s75, 10240
    buffer_load_dwordx4 v55, s[16:19], s75 offen nt lds
L_nopiece6:
    buffer_load_dwordx2 a[116:117], v54, s[4:7], s74 offen offset:0
    buffer_load_dwordx2 a[118:119], v54, s[4:7], s74 offen offset:256
    buffer_load_dwordx2 a[120:121], v54, s[4:7], s74 offen offset:512
    buffer_load_dwordx2 a[122:123], v54, s[4:7], s74 offen offset:768
    buffer_load_dwordx2 a[124:125], v54, s[4:7], s74 offen offset:1024
    s_mov_b32 s8, s78
    s_mov_b32 s9, s79
    s_mov_b32 s10, 1966080
    s_mov_b32 s11, 0x00020000
    s_mov_b32 s32, s90
    s_mov_b32 s33, s91
    s_mov_b32 s34, 18874368
    s_mov_b32 s35, 0x00020000
    s_mov_b32 s12, s80
    s_mov_b32 s13, s81
    s_mov_b32 s14, 3072
    s_mov_b32 s15, 0x00020000
    s_mov_b32 s20, s84
    s_mov_b32 s21, s85
    s_mov_b32 s22, 1280
    s_mov_b32 s23, 0x00020000
    s_mov_b32 s24, s86
    s_mov_b32 s25, s87
    s_mov_b32 s26, 2621440
    s_mov_b32 s27, 0x00020000
    v_lshlrev_b32 v19, 3, v3
    v_bfe_u32 v18, v1, 2, 2
    v_add_u32 v19, v19, v18
    v_mul_u32_u24 v19, 192, v19
    v_bfe_u32 v18, v1, 4, 1
    v_lshl_add_u32 v19, v18, 5, v19
    v_and_b32 v18, 3, v1
    v_lshl_add_u32 v19, v18, 3, v19
    v_and_b32 v20, 7, v1
    v_bfe_u32 v18, v1, 4, 1
    v_lshl_add_u32 v21, v18, 3, v20
    v_lshlrev_b32 v21, 8, v21
    v_bfe_u32 v18, v1, 3, 1
    v_lshl_add_u32 v21, v18, 7, v21
    v_add_u32 v21, s56, v21
    s_add_u32 s46, s36, 0
    s_and_b32 s46, s46, 3
    s_mul_i32 s47, s46, 3072
    v_add_u32 v32, s47, v19
    s_lshl_b32 s46, s46, 1
    v_add_u32 v18, s46, v3
    v_xor_b32 v18, v18, v20
    v_lshl_add_u32 v36, v18, 4, v21
    s_add_u32 s46, s36, 1
    s_and_b32 s46, s46, 3
    s_mul_i32 s47, s46, 3072
    v_add_u32 v33, s47, v19
    s_lshl_b32 s46, s46, 1
    v_add_u32 v18, s46, v3
    v_xor_b32 v18, v18, v20
    v_lshl_add_u32 v37, v18, 4, v21
    s_add_u32 s46, s36, 2
    s_and_b32 s46, s46, 3
    s_mul_i32 s47, s46, 3072
    v_add_u32 v34, s47, v19
    s_lshl_b32 s46, s46, 1
    v_add_u32 v18, s46, v3
    v_xor_b32 v18, v18, v20
    v_lshl_add_u32 v38, v18, 4, v21
    s_add_u32 s46, s36, 3
    s_and_b32 s46, s46, 3
    s_mul_i32 s47, s46, 3072
    v_add_u32 v35, s47, v19
    s_lshl_b32 s46, s46, 1
    v_add_u32 v18, s46, v3
    v_xor_b32 v18, v18, v20
    v_lshl_add_u32 v39, v18, 4, v21
    v_mov_b32 v12, 0x3f803f80
    v_accvgpr_write_b32 a112, v12
    v_accvgpr_write_b32 a113, v12
    v_accvgpr_write_b32 a114, v12
    v_accvgpr_write_b32 a115, v12
    s_lshl_b32 s46, s40, 7
    s_lshl_b32 s47, s36, 2
    s_add_u32 s46, s46, s47
    s_add_u32 s46, s46, 12582976
    v_mov_b32 v6, s46
    s_mul_i32 s49, s43, 3
    s_lshr_b32 s49, s49, 2
    s_mul_i32 s88, s36, 6
    s_mul_i32 s89, s42, 48
    s_add_u32 s89, s89, s88
    s_add_u32 s46, s49, s88
    s_lshl_b32 s82, s46, 10
    s_add_u32 s46, s49, s89
    s_mul_i32 s76, s46, 5120
    s_add_u32 s49, s49, 1
    s_cmp_eq_u32 s49, 6
    s_cselect_b32 s49, 0, s49
    s_add_u32 s46, s49, s88
    s_lshl_b32 s83, s46, 10
    s_add_u32 s46, s49, s89
    s_mul_i32 s77, s46, 5120
    s_add_u32 s49, s49, 1
    s_cmp_eq_u32 s49, 6
    s_cselect_b32 s49, 0, s49
    s_add_u32 s46, s49, s88
    s_lshl_b32 s84, s46, 10
    s_add_u32 s46, s49, s89
    s_mul_i32 s78, s46, 5120
    s_add_u32 s49, s49, 1
    s_cmp_eq_u32 s49, 6
    s_cselect_b32 s49, 0, s49
    s_add_u32 s46, s49, s88
    s_lshl_b32 s85, s46, 10
    s_add_u32 s46, s49, s89
    s_mul_i32 s79, s46, 5120
    s_add_u32 s49, s49, 1
    s_cmp_eq_u32 s49, 6
    s_cselect_b32 s49, 0, s49
    s_add_u32 s46, s49, s88
    s_lshl_b32 s86, s46, 10
    s_add_u32 s46, s49, s89
    s_mul_i32 s80, s46, 5120
    s_add_u32 s49, s49, 1
    s_cmp_eq_u32 s49, 6
    s_cselect_b32 s49, 0, s49
    s_add_u32 s46, s49, s88
    s_lshl_b32 s87, s46, 10
    s_add_u32 s46, s49, s89
    s_mul_i32 s81, s46, 5120
    s_add_u32 s49, s49, 1
    s_cmp_eq_u32 s49, 6
    s_cselect_b32 s49, 0, s49
    s_add_u32 s46, s36, 1
    s_and_b32 s46, s46, 3
    s_lshl_b32 s47, s41, 2
    s_add_u32 s46, s46, s47
    s_mul_i32 s46, s46, 49152
    s_add_u32 s52, s46, 4194304
    s_add_u32 s46, s36, 2
    s_and_b32 s46, s46, 3
    s_lshl_b32 s47, s41, 2
    s_add_u32 s46, s46, s47
    s_mul_i32 s46, s46, 49152
    s_add_u32 s53, s46, 4194304
    s_add_u32 s46, s36, 3
    s_and_b32 s46, s46, 3
    s_lshl_b32 s47, s41, 2
    s_add_u32 s46, s46, s47
    s_mul_i32 s46, s46, 49152
    s_add_u32 s54, s46, 4194304
    s_add_u32 s46, s36, 4
    s_and_b32 s46, s46, 3
    s_lshl_b32 s47, s41, 2
    s_add_u32 s46, s46, s47
    s_mul_i32 s46, s46, 49152
    s_add_u32 s55, s46, 4194304
    v_cmp_le_u32 vcc, 6, v1
    s_mul_i32 s46, s42, 5
    s_nop 0
    v_cndmask_b32 v19, 0, 1, vcc
    v_lshl_add_u32 v18, v19, 2, s46
    v_lshrrev_b32 v18, 3, v18
    v_mul_u32_u24 v18, 48, v18
    v_mul_u32_u24 v19, 6, v19
    v_sub_u32 v19, v1, v19
    v_add3_u32 v18, v18, v19, s88
    v_cmp_gt_u32 vcc, 12, v1
    v_readfirstlane_b32 s46, v18
    s_nop 1
    v_mov_b32 v19, s46
    v_cndmask_b32 v45, v19, v18, vcc
    v_lshlrev_b32 v45, 7, v45
    v_add_u32 v45, 12582976, v45
    s_lshl_b32 s46, s38, 4
    s_lshl_b32 s47, s36, 1
    s_add_u32 s46, s46, s47
    v_and_b32 v19, 1, v1
    v_add_u32 v19, s46, v19
    s_and_b32 s47, s41, 1
    s_lshl_b32 s47, s47, 3
    s_add_u32 s47, s47, 12582976
    v_lshlrev_b32 v7, 7, v19
    v_add_u32 v7, s47, v7
    s_lshl_b32 s46, s38, 4
    s_lshl_b32 s47, s36, 2
    s_add_u32 s46, s46, s47
    v_lshrrev_b32 v19, 3, v4
    v_add_u32 v19, s46, v19
    v_lshlrev_b32 v41, 7, v19
    v_bfe_u32 v19, v4, 1, 2
    v_lshl_add_u32 v41, v19, 4, v41
    v_add_u32 v41, 12582912, v41
    v_bfe_u32 v18, v1, 4, 1
    v_mul_u32_u24 v40, 49152, v18
    v_lshl_add_u32 v40, v3, 8, v40
    v_and_b32 v18, 15, v1
    v_lshl_add_u32 v40, v18, 4, v40
    s_lshl_b32 s46, s38, 3
    s_lshl_b32 s47, s36, 1
    s_add_u32 s46, s46, s47
    s_mul_i32 s46, s46, 49152
    s_mul_i32 s47, s39, 3072
    s_add_u32 s46, s46, s47
    s_add_u32 s58, s46, 4194304
    v_mov_b32 v46, 0xbdd2d3e8
    v_mov_b32 v47, 0xbdd2d3e8
    v_mov_b32 v48, 0xc0135761
    v_mov_b32 v49, 0xc0135761
    v_mov_b32 v50, 1.0
    v_mov_b32 v51, 1.0
    v_mov_b32 v78, 0
    v_mov_b32 v79, 0
    v_lshlrev_b32 v30, 11, v3
    v_bfe_u32 v18, v1, 4, 1
    v_lshl_add_u32 v30, v18, 9, v30
    v_bfe_u32 v18, v1, 2, 2
    v_lshl_add_u32 v30, v18, 7, v30
    v_and_b32 v18, 3, v1
    v_lshl_add_u32 v30, v18, 3, v30
    s_and_b32 s46, s37, 1
    s_lshl_b32 s46, s46, 12
    s_add_u32 s46, s46, 155648
    v_add_u32 v30, s46, v30
    s_mov_b32 s70, 0x3f803f80
    s_lshl_b32 s46, s61, 3
    s_lshl_b32 s47, s37, 2
    s_add_u32 s46, s46, s47
    s_add_u32 s46, s46, 0
    s_mul_i32 s47, s46, 13108
    s_lshr_b32 s47, s47, 16
    s_mul_i32 s48, s47, 5
    s_sub_u32 s46, s46, s48
    s_mul_i32 s47, s47, 48
    s_add_u32 s47, s47, s62
    s_mul_i32 s47, s47, 5
    s_add_u32 s46, s46, s47
    s_lshl_b32 s46, s46, 10
    s_cmp_lg_u32 s71, 0
    s_cselect_b32 s63, 18874368, s46
    s_lshl_b32 s46, s61, 3
    s_lshl_b32 s47, s37, 2
    s_add_u32 s46, s46, s47
    s_add_u32 s46, s46, 1
    s_mul_i32 s47, s46, 13108
    s_lshr_b32 s47, s47, 16
    s_mul_i32 s48, s47, 5
    s_sub_u32 s46, s46, s48
    s_mul_i32 s47, s47, 48
    s_add_u32 s47, s47, s62
    s_mul_i32 s47, s47, 5
    s_add_u32 s46, s46, s47
    s_lshl_b32 s46, s46, 10
    s_cmp_lg_u32 s71, 0
    s_cselect_b32 s64, 18874368, s46
    s_lshl_b32 s46, s61, 3
    s_lshl_b32 s47, s37, 2
    s_add_u32 s46, s46, s47
    s_add_u32 s46, s46, 2
    s_mul_i32 s47, s46, 13108
    s_lshr_b32 s47, s47, 16
    s_mul_i32 s48, s47, 5
    s_sub_u32 s46, s46, s48
    s_mul_i32 s47, s47, 48
    s_add_u32 s47, s47, s62
    s_mul_i32 s47, s47, 5
    s_add_u32 s46, s46, s47
    s_lshl_b32 s46, s46, 10
    s_cmp_lg_u32 s71, 0
    s_cselect_b32 s72, 18874368, s46
    s_lshl_b32 s46, s61, 3
    s_lshl_b32 s47, s37, 2
    s_add_u32 s46, s46, s47
    s_add_u32 s46, s46, 3
    s_mul_i32 s47, s46, 13108
    s_lshr_b32 s47, s47, 16
    s_mul_i32 s48, s47, 5
    s_sub_u32 s46, s46, s48
    s_mul_i32 s47, s47, 48
    s_add_u32 s47, s47, s62
    s_mul_i32 s47, s47, 5
    s_add_u32 s46, s46, s47
    s_lshl_b32 s46, s46, 10
    s_cmp_lg_u32 s71, 0
    s_cselect_b32 s73, 18874368, s46
    s_barrier
    ds_read_b128 v[56:59], v36 offset:0
    ds_read_b128 v[60:63], v37 offset:0
    ds_read_b128 v[64:67], v38 offset:0
    ds_read_b128 v[68:71], v39 offset:0
    ds_read_b64_tr_b16 a[0:1], v32 offset:0
    ds_read_b64_tr_b16 a[2:3], v32 offset:768
    ds_read_b64_tr_b16 a[4:5], v32 offset:64
    ds_read_b64_tr_b16 a[6:7], v32 offset:832
    ds_read_b64_tr_b16 a[8:9], v32 offset:128
    ds_read_b64_tr_b16 a[10:11], v32 offset:896
    ds_read_b64_tr_b16 a[12:13], v33 offset:0
    ds_read_b64_tr_b16 a[14:15], v33 offset:768
    ds_read_b64_tr_b16 a[16:17], v33 offset:64
    ds_read_b64_tr_b16 a[18:19], v33 offset:832
    ds_read_b64_tr_b16 a[20:21], v33 offset:128
    ds_read_b64_tr_b16 a[22:23], v33 offset:896
    s_waitcnt lgkmcnt(10)
    v_mfma_f32_4x4x4_16b_bf16 a[48:51], a[112:113], a[0:1], 0
    v_mfma_f32_32x32x16_bf16 v[80:95], a[0:3], v[56:59], 0
    ds_read_b64_tr_b16 a[24:25], v34 offset:0
    ds_read_b64_tr_b16 a[26:27], v34 offset:768
    v_mfma_f32_4x4x4_16b_bf16 a[48:51], a[112:113], a[2:3], a[48:51]
    s_waitcnt lgkmcnt(10)
    v_mfma_f32_4x4x4_16b_bf16 a[52:55], a[112:113], a[4:5], 0
    v_mfma_f32_32x32x16_bf16 v[96:111], a[4:7], v[56:59], 0
    ds_read_b64_tr_b16 a[28:29], v34 offset:64
    ds_read_b64_tr_b16 a[30:31], v34 offset:832
    v_mfma_f32_4x4x4_16b_bf16 a[52:55], a[112:113], a[6:7], a[52:55]
    s_waitcnt lgkmcnt(10)
    v_mfma_f32_4x4x4_16b_bf16 a[56:59], a[112:113], a[8:9], 0
    v_mfma_f32_32x32x16_bf16 v[112:127], a[8:11], v[56:59], 0
    ds_read_b64_tr_b16 a[32:33], v34 offset:128
    ds_read_b64_tr_b16 a[34:35], v34 offset:896
    v_mfma_f32_4x4x4_16b_bf16 a[56:59], a[112:113], a[10:11], a[56:59]
    s_waitcnt lgkmcnt(10)
    v_mfma_f32_32x32x16_bf16 v[80:95], a[12:15], v[60:63], v[80:95]
    ds_read_b64_tr_b16 a[36:37], v35 offset:0
    ds_read_b64_tr_b16 a[38:39], v35 offset:768
    s_waitcnt lgkmcnt(10)
    v_mfma_f32_32x32x16_bf16 v[96:111], a[16:19], v[60:63], v[96:111]
    ds_read_b64_tr_b16 a[40:41], v35 offset:64
    ds_read_b64_tr_b16 a[42:43], v35 offset:832
    s_waitcnt lgkmcnt(10)
    v_mfma_f32_32x32x16_bf16 v[112:127], a[20:23], v[60:63], v[112:127]
    ds_read_b64_tr_b16 a[44:45], v35 offset:128
    ds_read_b64_tr_b16 a[46:47], v35 offset:896
    s_waitcnt vmcnt(0)
    ds_read_b64_tr_b16 v[12:13], v30 offset:0
    ds_read_b64_tr_b16 v[14:15], v30 offset:1024
    ds_read_b64_tr_b16 v[16:17], v30 offset:32
    ds_read_b64_tr_b16 v[18:19], v30 offset:1056
    s_waitcnt lgkmcnt(0)
    buffer_store_dwordx4 v[12:15], v2, s[32:35], s63 offen sc1
    buffer_store_dwordx4 v[16:19], v2, s[32:35], s64 offen sc1
    s_nop 1
    ds_read_b64_tr_b16 v[12:13], v30 offset:64
    ds_read_b64_tr_b16 v[14:15], v30 offset:1088
    ds_read_b64_tr_b16 v[16:17], v30 offset:96
    ds_read_b64_tr_b16 v[18:19], v30 offset:1120
    s_waitcnt lgkmcnt(0)
    buffer_store_dwordx4 v[12:15], v2, s[32:35], s72 offen sc1
    buffer_store_dwordx4 v[16:19], v2, s[32:35], s73 offen sc1
    buffer_load_dword v8, v5, s[28:31], 0 offen sc1
    s_barrier
    ds_read_b128 a[96:99], v36 offset:4096
    ds_read_b128 a[100:103], v37 offset:4096
    ds_read_b128 a[104:107], v38 offset:4096
    ds_read_b128 a[108:111], v39 offset:4096
    v_mfma_f32_32x32x16_bf16 v[80:95], a[24:27], v[64:67], v[80:95]
    ds_read_b64_tr_b16 a[0:1], v32 offset:12288
    ds_read_b64_tr_b16 a[2:3], v32 offset:13056
    v_mfma_f32_32x32x16_bf16 v[96:111], a[28:31], v[64:67], v[96:111]
    ds_read_b64_tr_b16 a[4:5], v32 offset:12352
    ds_read_b64_tr_b16 a[6:7], v32 offset:13120
    v_mfma_f32_32x32x16_bf16 v[112:127], a[32:35], v[64:67], v[112:127]
    ds_read_b64_tr_b16 a[8:9], v32 offset:12416
    ds_read_b64_tr_b16 a[10:11], v32 offset:13184
    v_mfma_f32_32x32x16_bf16 v[80:95], a[36:39], v[68:71], v[80:95]
    ds_read_b64_tr_b16 a[12:13], v33 offset:12288
    ds_read_b64_tr_b16 a[14:15], v33 offset:13056
    v_mfma_f32_32x32x16_bf16 v[96:111], a[40:43], v[68:71], v[96:111]
    ds_read_b64_tr_b16 a[16:17], v33 offset:12352
    ds_read_b64_tr_b16 a[18:19], v33 offset:13120
    v_mfma_f32_32x32x16_bf16 v[112:127], a[44:47], v[68:71], v[112:127]
    ds_read_b64_tr_b16 a[20:21], v33 offset:12416
    ds_read_b64_tr_b16 a[22:23], v33 offset:13184
    s_waitcnt lgkmcnt(10)
    v_mfma_f32_4x4x4_16b_bf16 a[48:51], a[112:113], a[0:1], a[48:51]
    v_mfma_f32_32x32x16_bf16 v[80:95], a[0:3], a[96:99], v[80:95]
    ds_read_b64_tr_b16 a[24:25], v34 offset:12288
    ds_read_b64_tr_b16 a[26:27], v34 offset:13056
    v_mfma_f32_4x4x4_16b_bf16 a[48:51], a[112:113], a[2:3], a[48:51]
    s_waitcnt lgkmcnt(10)
    v_mfma_f32_4x4x4_16b_bf16 a[52:55], a[112:113], a[4:5], a[52:55]
    v_mfma_f32_32x32x16_bf16 v[96:111], a[4:7], a[96:99], v[96:111]
    ds_read_b64_tr_b16 a[28:29], v34 offset:12352
    ds_read_b64_tr_b16 a[30:31], v34 offset:13120
    v_mfma_f32_4x4x4_16b_bf16 a[52:55], a[112:113], a[6:7], a[52:55]
    s_waitcnt lgkmcnt(10)
    v_mfma_f32_4x4x4_16b_bf16 a[56:59], a[112:113], a[8:9], a[56:59]
    v_mfma_f32_32x32x16_bf16 v[112:127], a[8:11], a[96:99], v[112:127]
    ds_read_b64_tr_b16 a[32:33], v34 offset:12416
    ds_read_b64_tr_b16 a[34:35], v34 offset:13184
    v_mfma_f32_4x4x4_16b_bf16 a[56:59], a[112:113], a[10:11], a[56:59]
    s_waitcnt lgkmcnt(10)
    v_mfma_f32_32x32x16_bf16 v[80:95], a[12:15], a[100:103], v[80:95]
    ds_read_b64_tr_b16 a[36:37], v35 offset:12288
    ds_read_b64_tr_b16 a[38:39], v35 offset:13056
    s_waitcnt lgkmcnt(10)
    v_mfma_f32_32x32x16_bf16 v[96:111], a[16:19], a[100:103], v[96:111]
    ds_read_b64_tr_b16 a[40:41], v35 offset:12352
    ds_read_b64_tr_b16 a[42:43], v35 offset:13120
    s_waitcnt lgkmcnt(10)
    v_mfma_f32_32x32x16_bf16 v[112:127], a[20:23], a[100:103], v[112:127]
    ds_read_b64_tr_b16 a[44:45], v35 offset:12416
    ds_read_b64_tr_b16 a[46:47], v35 offset:13184
    v_accvgpr_read_b32 v12, a116
    v_accvgpr_read_b32 v13, a117
    v_accvgpr_read_b32 v14, a118
    v_accvgpr_read_b32 v15, a119
    v_accvgpr_read_b32 v16, a120
    v_accvgpr_read_b32 v17, a121
    v_accvgpr_read_b32 v18, a122
    v_accvgpr_read_b32 v19, a123
    v_accvgpr_read_b32 v20, a124
    v_accvgpr_read_b32 v21, a125
    v_lshlrev_b32 v25, 16, v12
    v_and_b32 v26, 0xffff0000, v12
    v_mov_b32 v22, v25
    v_mov_b32 v23, v26
    v_lshlrev_b32 v25, 16, v13
    v_and_b32 v26, 0xffff0000, v13
    v_add_f32 v22, v22, v25
    v_add_f32 v23, v23, v26
    v_lshlrev_b32 v25, 16, v14
    v_and_b32 v26, 0xffff0000, v14
    v_add_f32 v22, v22, v25
    v_add_f32 v23, v23, v26
    v_lshlrev_b32 v25, 16, v15
    v_and_b32 v26, 0xffff0000, v15
    v_add_f32 v22, v22, v25
    v_add_f32 v23, v23, v26
    v_lshlrev_b32 v25, 16, v16
    v_and_b32 v26, 0xffff0000, v16
    v_add_f32 v22, v22, v25
    v_add_f32 v23, v23, v26
    v_lshlrev_b32 v25, 16, v17
    v_and_b32 v26, 0xffff0000, v17
    v_add_f32 v22, v22, v25
    v_add_f32 v23, v23, v26
    v_lshlrev_b32 v25, 16, v18
    v_and_b32 v26, 0xffff0000, v18
    v_add_f32 v22, v22, v25
    v_add_f32 v23, v23, v26
    v_lshlrev_b32 v25, 16, v19
    v_and_b32 v26, 0xffff0000, v19
    v_add_f32 v22, v22, v25
    v_add_f32 v23, v23, v26
    v_lshlrev_b32 v25, 16, v20
    v_and_b32 v26, 0xffff0000, v20
    v_add_f32 v22, v22, v25
    v_add_f32 v23, v23, v26
    v_lshlrev_b32 v25, 16, v21
    v_and_b32 v26, 0xffff0000, v21
    v_add_f32 v22, v22, v25
    v_add_f32 v23, v23, v26
    v_add_f32 v22, v22, v23
    s_nop 1
    v_add_f32_dpp v22, v22, v22 row_ror:8 row_mask:0xf bank_mask:0xf
    s_nop 1
    v_add_f32_dpp v22, v22, v22 row_ror:4 row_mask:0xf bank_mask:0xf
    s_nop 1
    v_add_f32_dpp v22, v22, v22 row_ror:2 row_mask:0xf bank_mask:0xf
    s_nop 1
    v_add_f32_dpp v22, v22, v22 row_ror:1 row_mask:0xf bank_mask:0xf
    v_mov_b32 v23, v22
    s_nop 1
    v_permlane16_swap_b32 v22, v23
    s_nop 1
    v_add_f32 v22, v22, v23
    v_mul_f32 v22, 0x3acccccd, v22
    v_cvt_pk_bf16_f32 v24, v22, v22
    v_lshlrev_b32 v24, 16, v24
    v_sub_f32 v22, v22, v24
    v_lshlrev_b32 v25, 16, v12
    v_and_b32 v26, 0xffff0000, v12
    v_sub_f32 v25, v25, v24
    v_sub_f32 v26, v26, v24
    v_mul_f32 v27, v25, v25
    v_mul_f32 v28, v26, v26
    v_lshlrev_b32 v25, 16, v13
    v_and_b32 v26, 0xffff0000, v13
    v_sub_f32 v25, v25, v24
    v_sub_f32 v26, v26, v24
    v_fmac_f32 v27, v25, v25
    v_fmac_f32 v28, v26, v26
    v_lshlrev_b32 v25, 16, v14
    v_and_b32 v26, 0xffff0000, v14
    v_sub_f32 v25, v25, v24
    v_sub_f32 v26, v26, v24
    v_fmac_f32 v27, v25, v25
    v_fmac_f32 v28, v26, v26
    v_lshlrev_b32 v25, 16, v15
    v_and_b32 v26, 0xffff0000, v15
    v_sub_f32 v25, v25, v24
    v_sub_f32 v26, v26, v24
    v_fmac_f32 v27, v25, v25
    v_fmac_f32 v28, v26, v26
    v_lshlrev_b32 v25, 16, v16
    v_and_b32 v26, 0xffff0000, v16
    v_sub_f32 v25, v25, v24
    v_sub_f32 v26, v26, v24
    v_fmac_f32 v27, v25, v25
    v_fmac_f32 v28, v26, v26
    v_lshlrev_b32 v25, 16, v17
    v_and_b32 v26, 0xffff0000, v17
    v_sub_f32 v25, v25, v24
    v_sub_f32 v26, v26, v24
    v_fmac_f32 v27, v25, v25
    v_fmac_f32 v28, v26, v26
    v_lshlrev_b32 v25, 16, v18
    v_and_b32 v26, 0xffff0000, v18
    v_sub_f32 v25, v25, v24
    v_sub_f32 v26, v26, v24
    v_fmac_f32 v27, v25, v25
    v_fmac_f32 v28, v26, v26
    v_lshlrev_b32 v25, 16, v19
    v_and_b32 v26, 0xffff0000, v19
    v_sub_f32 v25, v25, v24
    v_sub_f32 v26, v26, v24
    v_fmac_f32 v27, v25, v25
    v_fmac_f32 v28, v26, v26
    v_lshlrev_b32 v25, 16, v20
    v_and_b32 v26, 0xffff0000, v20
    v_sub_f32 v25, v25, v24
    v_sub_f32 v26, v26, v24
    v_fmac_f32 v27, v25, v25
    v_fmac_f32 v28, v26, v26
    v_lshlrev_b32 v25, 16, v21
    v_and_b32 v26, 0xffff0000, v21
    v_sub_f32 v25, v25, v24
    v_sub_f32 v26, v26, v24
    v_fmac_f32 v27, v25, v25
    v_fmac_f32 v28, v26, v26
    v_add_f32 v27, v27, v28
    s_nop 1
    v_add_f32_dpp v27, v27, v27 row_ror:8 row_mask:0xf bank_mask:0xf
    s_nop 1
    v_add_f32_dpp v27, v27, v27 row_ror:4 row_mask:0xf bank_mask:0xf
    s_nop 1
    v_add_f32_dpp v27, v27, v27 row_ror:2 row_mask:0xf bank_mask:0xf
    s_nop 1
    v_add_f32_dpp v27, v27, v27 row_ror:1 row_mask:0xf bank_mask:0xf
    v_mov_b32 v28, v27
    s_nop 1
    v_permlane16_swap_b32 v27, v28
    s_nop 1
    v_add_f32 v27, v27, v28
    v_mul_f32 v27, 0x3acccccd, v27
    v_fma_f32 v27, -v22, v22, v27
    v_max_f32 v27, 0, v27
    v_cvt_pk_bf16_f32 v27, v27, v27
    v_lshlrev_b32 v27, 16, v27
    v_add_f32 v27, 0x3727c5ac, v27
    v_cvt_pk_bf16_f32 v27, v27, v27
    v_lshlrev_b32 v27, 16, v27
    v_sqrt_f32 v27, v27
    s_nop 0
    v_cvt_pk_bf16_f32 v72, v24, v27
    s_waitcnt vmcnt(0)
    v_readfirstlane_b32 s45, v8
    s_nop 3
    s_cmp_lg_u32 s45, 0
    s_cbranch_scc1 L_ok7
    s_mov_b32 s49, 60000
L_retry8:
    s_sub_u32 s49, s49, 1
    s_cmp_eq_u32 s49, 0
    s_cbranch_scc1 L_ok7
    buffer_load_dword v8, v5, s[28:31], 0 offen sc1
    s_waitcnt vmcnt(0)
    v_readfirstlane_b32 s45, v8
    s_nop 3
    s_cmp_lg_u32 s45, 0
    s_cbranch_scc0 L_retry8
L_ok7:
    v_readlane_b32 s46, v72, 32
    v_mov_b32 v22, s45
    v_mov_b32 v23, v72
    v_mov_b32 v25, s45
    v_mov_b32 v24, s46
    s_lshl_b32 s46, s40, 7
    s_lshl_b32 s47, s37, 4
    s_add_u32 s46, s46, s47
    s_add_u32 s46, s46, 12582912
    v_mov_b32 v26, s46
    s_mov_b64 exec, 1
    buffer_store_dwordx4 v[22:25], v26, s[32:35], 0 offen sc1
    s_mov_b64 exec, -1
    s_barrier
    ds_read_b128 v[56:59], v36 offset:8192
    ds_read_b128 v[60:63], v37 offset:8192
    ds_read_b128 v[64:67], v38 offset:8192
    ds_read_b128 v[68:71], v39 offset:8192
    s_waitcnt lgkmcnt(14)
    v_mfma_f32_32x32x16_bf16 v[80:95], a[24:27], a[104:107], v[80:95]
    ds_read_b64_tr_b16 a[0:1], v32 offset:24576
    ds_read_b64_tr_b16 a[2:3], v32 offset:25344
    s_waitcnt lgkmcnt(14)
    v_mfma_f32_32x32x16_bf16 v[96:111], a[28:31], a[104:107], v[96:111]
    ds_read_b64_tr_b16 a[4:5], v32 offset:24640
    ds_read_b64_tr_b16 a[6:7], v32 offset:25408
    s_waitcnt lgkmcnt(14)
    v_mfma_f32_32x32x16_bf16 v[112:127], a[32:35], a[104:107], v[112:127]
    ds_read_b64_tr_b16 a[8:9], v32 offset:24704
    ds_read_b64_tr_b16 a[10:11], v32 offset:25472
    s_waitcnt lgkmcnt(14)
    v_mfma_f32_32x32x16_bf16 v[80:95], a[36:39], a[108:111], v[80:95]
    ds_read_b64_tr_b16 a[12:13], v33 offset:24576
    ds_read_b64_tr_b16 a[14:15], v33 offset:25344
    s_waitcnt lgkmcnt(14)
    v_mfma_f32_32x32x16_bf16 v[96:111], a[40:43], a[108:111], v[96:111]
    ds_read_b64_tr_b16 a[16:17], v33 offset:24640
    ds_read_b64_tr_b16 a[18:19], v33 offset:25408
    s_waitcnt lgkmcnt(14)
    v_mfma_f32_32x32x16_bf16 v[112:127], a[44:47], a[108:111], v[112:127]
    ds_read_b64_tr_b16 a[20:21], v33 offset:24704
    ds_read_b64_tr_b16 a[22:23], v33 offset:25472
    s_waitcnt lgkmcnt(10)
    v_mfma_f32_4x4x4_16b_bf16 a[48:51], a[112:113], a[0:1], a[48:51]
    v_mfma_f32_32x32x16_bf16 v[80:95], a[0:3], v[56:59], v[80:95]
    ds_read_b64_tr_b16 a[24:25], v34 offset:24576
    ds_read_b64_tr_b16 a[26:27], v34 offset:25344
    v_mfma_f32_4x4x4_16b_bf16 a[48:51], a[112:113], a[2:3], a[48:51]
    s_waitcnt lgkmcnt(10)
    v_mfma_f32_4x4x4_16b_bf16 a[52:55], a[112:113], a[4:5], a[52:55]
    v_mfma_f32_32x32x16_bf16 v[96:111], a[4:7], v[56:59], v[96:111]
    ds_read_b64_tr_b16 a[28:29], v34 offset:24640
    ds_read_b64_tr_b16 a[30:31], v34 offset:25408
    v_mfma_f32_4x4x4_16b_bf16 a[52:55], a[112:113], a[6:7], a[52:55]
    s_waitcnt lgkmcnt(10)
    v_mfma_f32_4x4x4_16b_bf16 a[56:59], a[112:113], a[8:9], a[56:59]
    v_mfma_f32_32x32x16_bf16 v[112:127], a[8:11], v[56:59], v[112:127]
    ds_read_b64_tr_b16 a[32:33], v34 offset:24704
    ds_read_b64_tr_b16 a[34:35], v34 offset:25472
    v_mfma_f32_4x4x4_16b_bf16 a[56:59], a[112:113], a[10:11], a[56:59]
    s_waitcnt lgkmcnt(10)
    v_mfma_f32_32x32x16_bf16 v[80:95], a[12:15], v[60:63], v[80:95]
    ds_read_b64_tr_b16 a[36:37], v35 offset:24576
    ds_read_b64_tr_b16 a[38:39], v35 offset:25344
    s_or_b32 s46, s45, 1
    v_mov_b32 v31, s46
    s_mov_b64 exec, 1
    buffer_store_dword v31, v6, s[32:35], 0 offen sc1
    s_mov_b64 exec, -1
    s_waitcnt lgkmcnt(10)
    v_mfma_f32_32x32x16_bf16 v[96:111], a[16:19], v[60:63], v[96:111]
    ds_read_b64_tr_b16 a[40:41], v35 offset:24640
    ds_read_b64_tr_b16 a[42:43], v35 offset:25408
    s_waitcnt lgkmcnt(10)
    v_mfma_f32_32x32x16_bf16 v[112:127], a[20:23], v[60:63], v[112:127]
    ds_read_b64_tr_b16 a[44:45], v35 offset:24704
    ds_read_b64_tr_b16 a[46:47], v35 offset:25472
    s_barrier
    ds_read_b128 a[96:99], v36 offset:12288
    ds_read_b128 a[100:103], v37 offset:12288
    ds_read_b128 a[104:107], v38 offset:12288
    ds_read_b128 a[108:111], v39 offset:12288
    s_waitcnt lgkmcnt(14)
    v_mfma_f32_32x32x16_bf16 v[80:95], a[24:27], v[64:67], v[80:95]
    ds_read_b64_tr_b16 a[0:1], v32 offset:36864
    ds_read_b64_tr_b16 a[2:3], v32 offset:37632
    s_waitcnt lgkmcnt(14)
    v_mfma_f32_32x32x16_bf16 v[96:111], a[28:31], v[64:67], v[96:111]
    ds_read_b64_tr_b16 a[4:5], v32 offset:36928
    ds_read_b64_tr_b16 a[6:7], v32 offset:37696
    s_waitcnt lgkmcnt(14)
    v_mfma_f32_32x32x16_bf16 v[112:127], a[32:35], v[64:67], v[112:127]
    ds_read_b64_tr_b16 a[8:9], v32 offset:36992
    ds_read_b64_tr_b16 a[10:11], v32 offset:37760
    s_waitcnt lgkmcnt(14)
    v_mfma_f32_32x32x16_bf16 v[80:95], a[36:39], v[68:71], v[80:95]
    ds_read_b64_tr_b16 a[12:13], v33 offset:36864
    ds_read_b64_tr_b16 a[14:15], v33 offset:37632
    s_waitcnt lgkmcnt(14)
    v_mfma_f32_32x32x16_bf16 v[96:111], a[40:43], v[68:71], v[96:111]
    ds_read_b64_tr_b16 a[16:17], v33 offset:36928
    ds_read_b64_tr_b16 a[18:19], v33 offset:37696
    s_waitcnt lgkmcnt(14)
    v_mfma_f32_32x32x16_bf16 v[112:127], a[44:47], v[68:71], v[112:127]
    ds_read_b64_tr_b16 a[20:21], v33 offset:36992
    ds_read_b64_tr_b16 a[22:23], v33 offset:37760
    s_waitcnt lgkmcnt(10)
    v_mfma_f32_4x4x4_16b_bf16 a[48:51], a[112:113], a[0:1], a[48:51]
    v_mfma_f32_32x32x16_bf16 v[80:95], a[0:3], a[96:99], v[80:95]
    ds_read_b64_tr_b16 a[24:25], v34 offset:36864
    ds_read_b64_tr_b16 a[26:27], v34 offset:37632
    v_mfma_f32_4x4x4_16b_bf16 a[48:51], a[112:113], a[2:3], a[48:51]
    s_waitcnt lgkmcnt(10)
    v_mfma_f32_4x4x4_16b_bf16 a[52:55], a[112:113], a[4:5], a[52:55]
    v_mfma_f32_32x32x16_bf16 v[96:111], a[4:7], a[96:99], v[96:111]
    ds_read_b64_tr_b16 a[28:29], v34 offset:36928
    ds_read_b64_tr_b16 a[30:31], v34 offset:37696
    v_mfma_f32_4x4x4_16b_bf16 a[52:55], a[112:113], a[6:7], a[52:55]
    s_waitcnt lgkmcnt(10)
    v_mfma_f32_4x4x4_16b_bf16 a[56:59], a[112:113], a[8:9], a[56:59]
    v_mfma_f32_32x32x16_bf16 v[112:127], a[8:11], a[96:99], v[112:127]
    ds_read_b64_tr_b16 a[32:33], v34 offset:36992
    ds_read_b64_tr_b16 a[34:35], v34 offset:37760
    v_mfma_f32_4x4x4_16b_bf16 a[56:59], a[112:113], a[10:11], a[56:59]
    s_waitcnt lgkmcnt(10)
    v_mfma_f32_32x32x16_bf16 v[80:95], a[12:15], a[100:103], v[80:95]
    ds_read_b64_tr_b16 a[36:37], v35 offset:36864
    ds_read_b64_tr_b16 a[38:39], v35 offset:37632
    s_waitcnt lgkmcnt(10)
    v_mfma_f32_32x32x16_bf16 v[96:111], a[16:19], a[100:103], v[96:111]
    ds_read_b64_tr_b16 a[40:41], v35 offset:36928
    ds_read_b64_tr_b16 a[42:43], v35 offset:37696
    s_waitcnt lgkmcnt(10)
    v_mfma_f32_32x32x16_bf16 v[112:127], a[20:23], a[100:103], v[112:127]
    ds_read_b64_tr_b16 a[44:45], v35 offset:36992
    ds_read_b64_tr_b16 a[46:47], v35 offset:37760
    s_barrier
    ds_read_b128 v[56:59], v36 offset:16384
    ds_read_b128 v[60:63], v37 offset:16384
    ds_read_b128 v[64:67], v38 offset:16384
    ds_read_b128 v[68:71], v39 offset:16384
    s_waitcnt lgkmcnt(14)
    v_mfma_f32_32x32x16_bf16 v[80:95], a[24:27], a[104:107], v[80:95]
    ds_read_b64_tr_b16 a[0:1], v32 offset:49152
    ds_read_b64_tr_b16 a[2:3], v32 offset:49920
    s_waitcnt lgkmcnt(14)
    v_mfma_f32_32x32x16_bf16 v[96:111], a[28:31], a[104:107], v[96:111]
    ds_read_b64_tr_b16 a[4:5], v32 offset:49216
    ds_read_b64_tr_b16 a[6:7], v32 offset:49984
    s_waitcnt lgkmcnt(14)
    v_mfma_f32_32x32x16_bf16 v[112:127], a[32:35], a[104:107], v[112:127]
    ds_read_b64_tr_b16 a[8:9], v32 offset:49280
    ds_read_b64_tr_b16 a[10:11], v32 offset:50048
    s_waitcnt lgkmcnt(14)
    v_mfma_f32_32x32x16_bf16 v[80:95], a[36:39], a[108:111], v[80:95]
    ds_read_b64_tr_b16 a[12:13], v33 offset:49152
    ds_read_b64_tr_b16 a[14:15], v33 offset:49920
    s_waitcnt lgkmcnt(14)
    v_mfma_f32_32x32x16_bf16 v[96:111], a[40:43], a[108:111], v[96:111]
    ds_read_b64_tr_b16 a[16:17], v33 offset:49216
    ds_read_b64_tr_b16 a[18:19], v33 offset:49984
    s_waitcnt lgkmcnt(14)
    v_mfma_f32_32x32x16_bf16 v[112:127], a[44:47], a[108:111], v[112:127]
    ds_read_b64_tr_b16 a[20:21], v33 offset:49280
    ds_read_b64_tr_b16 a[22:23], v33 offset:50048
    s_waitcnt lgkmcnt(10)
    v_mfma_f32_4x4x4_16b_bf16 a[48:51], a[112:113], a[0:1], a[48:51]
    v_mfma_f32_32x32x16_bf16 v[80:95], a[0:3], v[56:59], v[80:95]
    ds_read_b64_tr_b16 a[24:25], v34 offset:49152
    ds_read_b64_tr_b16 a[26:27], v34 offset:49920
    v_mfma_f32_4x4x4_16b_bf16 a[48:51], a[112:113], a[2:3], a[48:51]
    s_waitcnt lgkmcnt(10)
    v_mfma_f32_4x4x4_16b_bf16 a[52:55], a[112:113], a[4:5], a[52:55]
    v_mfma_f32_32x32x16_bf16 v[96:111], a[4:7], v[56:59], v[96:111]
    ds_read_b64_tr_b16 a[28:29], v34 offset:49216
    ds_read_b64_tr_b16 a[30:31], v34 offset:49984
    v_mfma_f32_4x4x4_16b_bf16 a[52:55], a[112:113], a[6:7], a[52:55]
    s_waitcnt lgkmcnt(10)
    v_mfma_f32_4x4x4_16b_bf16 a[56:59], a[112:113], a[8:9], a[56:59]
    v_mfma_f32_32x32x16_bf16 v[112:127], a[8:11], v[56:59], v[112:127]
    ds_read_b64_tr_b16 a[32:33], v34 offset:49280
    ds_read_b64_tr_b16 a[34:35], v34 offset:50048
    v_mfma_f32_4x4x4_16b_bf16 a[56:59], a[112:113], a[10:11], a[56:59]
    s_waitcnt lgkmcnt(10)
    v_mfma_f32_32x32x16_bf16 v[80:95], a[12:15], v[60:63], v[80:95]
    ds_read_b64_tr_b16 a[36:37], v35 offset:49152
    ds_read_b64_tr_b16 a[38:39], v35 offset:49920
    s_waitcnt lgkmcnt(10)
    v_mfma_f32_32x32x16_bf16 v[96:111], a[16:19], v[60:63], v[96:111]
    ds_read_b64_tr_b16 a[40:41], v35 offset:49216
    ds_read_b64_tr_b16 a[42:43], v35 offset:49984
    s_waitcnt lgkmcnt(10)
    v_mfma_f32_32x32x16_bf16 v[112:127], a[20:23], v[60:63], v[112:127]
    ds_read_b64_tr_b16 a[44:45], v35 offset:49280
    ds_read_b64_tr_b16 a[46:47], v35 offset:50048
    s_barrier
    ds_read_b128 a[96:99], v36 offset:0
    ds_read_b128 a[100:103], v37 offset:0
    ds_read_b128 a[104:107], v38 offset:0
    ds_read_b128 a[108:111], v39 offset:0
    s_waitcnt lgkmcnt(14)
    v_mfma_f32_32x32x16_bf16 v[80:95], a[24:27], v[64:67], v[80:95]
    ds_read_b64_tr_b16 a[0:1], v32 offset:61440
    ds_read_b64_tr_b16 a[2:3], v32 offset:62208
    s_waitcnt lgkmcnt(14)
    v_mfma_f32_32x32x16_bf16 v[96:111], a[28:31], v[64:67], v[96:111]
    ds_read_b64_tr_b16 a[4:5], v32 offset:61504
    ds_read_b64_tr_b16 a[6:7], v32 offset:62272
    s_waitcnt lgkmcnt(14)
    v_mfma_f32_32x32x16_bf16 v[112:127], a[32:35], v[64:67], v[112:127]
    ds_read_b64_tr_b16 a[8:9], v32 offset:61568
    ds_read_b64_tr_b16 a[10:11], v32 offset:62336
    s_waitcnt lgkmcnt(14)
    v_mfma_f32_32x32x16_bf16 v[80:95], a[36:39], v[68:71], v[80:95]
    ds_read_b64_tr_b16 a[12:13], v33 offset:61440
    ds_read_b64_tr_b16 a[14:15], v33 offset:62208
    s_waitcnt lgkmcnt(14)
    v_mfma_f32_32x32x16_bf16 v[96:111], a[40:43], v[68:71], v[96:111]
    ds_read_b64_tr_b16 a[16:17], v33 offset:61504
    ds_read_b64_tr_b16 a[18:19], v33 offset:62272
    s_waitcnt lgkmcnt(14)
    v_mfma_f32_32x32x16_bf16 v[112:127], a[44:47], v[68:71], v[112:127]
    ds_read_b64_tr_b16 a[20:21], v33 offset:61568
    ds_read_b64_tr_b16 a[22:23], v33 offset:62336
    s_waitcnt lgkmcnt(10)
    v_mfma_f32_4x4x4_16b_bf16 a[48:51], a[112:113], a[0:1], a[48:51]
    v_mfma_f32_32x32x16_bf16 v[80:95], a[0:3], a[96:99], v[80:95]
    ds_read_b64_tr_b16 a[24:25], v34 offset:61440
    ds_read_b64_tr_b16 a[26:27], v34 offset:62208
    v_mfma_f32_4x4x4_16b_bf16 a[48:51], a[112:113], a[2:3], a[48:51]
    v_lshlrev_b32 v20, 1, v4
    buffer_load_ushort v42, v20, s[12:15], s60 offen offset:0
    buffer_load_ushort v43, v20, s[12:15], s60 offen offset:64
    buffer_load_ushort v44, v20, s[12:15], s60 offen offset:128
    s_waitcnt lgkmcnt(10)
    v_mfma_f32_4x4x4_16b_bf16 a[52:55], a[112:113], a[4:5], a[52:55]
    v_mfma_f32_32x32x16_bf16 v[96:111], a[4:7], a[96:99], v[96:111]
    ds_read_b64_tr_b16 a[28:29], v34 offset:61504
    ds_read_b64_tr_b16 a[30:31], v34 offset:62272
    v_mfma_f32_4x4x4_16b_bf16 a[52:55], a[112:113], a[6:7], a[52:55]
    s_waitcnt lgkmcnt(10)
    v_mfma_f32_4x4x4_16b_bf16 a[56:59], a[112:113], a[8:9], a[56:59]
    v_mfma_f32_32x32x16_bf16 v[112:127], a[8:11], a[96:99], v[112:127]
    ds_read_b64_tr_b16 a[32:33], v34 offset:61568
    ds_read_b64_tr_b16 a[34:35], v34 offset:62336
    v_mfma_f32_4x4x4_16b_bf16 a[56:59], a[112:113], a[10:11], a[56:59]
    s_waitcnt lgkmcnt(10)
    v_mfma_f32_32x32x16_bf16 v[80:95], a[12:15], a[100:103], v[80:95]
    ds_read_b64_tr_b16 a[36:37], v35 offset:61440
    ds_read_b64_tr_b16 a[38:39], v35 offset:62208
    s_waitcnt lgkmcnt(10)
    v_mfma_f32_32x32x16_bf16 v[96:111], a[16:19], a[100:103], v[96:111]
    ds_read_b64_tr_b16 a[40:41], v35 offset:61504
    ds_read_b64_tr_b16 a[42:43], v35 offset:62272
    s_waitcnt lgkmcnt(10)
    v_mfma_f32_32x32x16_bf16 v[112:127], a[20:23], a[100:103], v[112:127]
    ds_read_b64_tr_b16 a[44:45], v35 offset:61568
    ds_read_b64_tr_b16 a[46:47], v35 offset:62336
    s_barrier
    ds_read_b128 v[56:59], v36 offset:4096
    ds_read_b128 v[60:63], v37 offset:4096
    ds_read_b128 v[64:67], v38 offset:4096
    ds_read_b128 v[68:71], v39 offset:4096
    s_waitcnt lgkmcnt(14)
    v_mfma_f32_32x32x16_bf16 v[80:95], a[24:27], a[104:107], v[80:95]
    ds_read_b64_tr_b16 a[0:1], v32 offset:0
    ds_read_b64_tr_b16 a[2:3], v32 offset:768
    s_waitcnt lgkmcnt(14)
    v_mfma_f32_32x32x16_bf16 v[96:111], a[28:31], a[104:107], v[96:111]
    ds_read_b64_tr_b16 a[4:5], v32 offset:64
    ds_read_b64_tr_b16 a[6:7], v32 offset:832
    s_waitcnt lgkmcnt(14)
    v_mfma_f32_32x32x16_bf16 v[112:127], a[32:35], a[104:107], v[112:127]
    ds_read_b64_tr_b16 a[8:9], v32 offset:128
    ds_read_b64_tr_b16 a[10:11], v32 offset:896
    s_waitcnt lgkmcnt(14)
    v_mfma_f32_32x32x16_bf16 v[80:95], a[36:39], a[108:111], v[80:95]
    ds_read_b64_tr_b16 a[12:13], v33 offset:0
    ds_read_b64_tr_b16 a[14:15], v33 offset:768
    s_waitcnt lgkmcnt(14)
    v_mfma_f32_32x32x16_bf16 v[96:111], a[40:43], a[108:111], v[96:111]
    ds_read_b64_tr_b16 a[16:17], v33 offset:64
    ds_read_b64_tr_b16 a[18:19], v33 offset:832
    s_waitcnt lgkmcnt(14)
    v_mfma_f32_32x32x16_bf16 v[112:127], a[44:47], a[108:111], v[112:127]
    ds_read_b64_tr_b16 a[20:21], v33 offset:128
    ds_read_b64_tr_b16 a[22:23], v33 offset:896
    s_waitcnt lgkmcnt(10)
    v_mfma_f32_4x4x4_16b_bf16 a[48:51], a[112:113], a[0:1], a[48:51]
    v_mfma_f32_32x32x16_bf16 v[80:95], a[0:3], v[56:59], v[80:95]
    ds_read_b64_tr_b16 a[24:25], v34 offset:0
    ds_read_b64_tr_b16 a[26:27], v34 offset:768
    v_mfma_f32_4x4x4_16b_bf16 a[48:51], a[112:113], a[2:3], a[48:51]
    s_waitcnt lgkmcnt(10)
    v_mfma_f32_4x4x4_16b_bf16 a[52:55], a[112:113], a[4:5], a[52:55]
    v_mfma_f32_32x32x16_bf16 v[96:111], a[4:7], v[56:59], v[96:111]
    ds_read_b64_tr_b16 a[28:29], v34 offset:64
    ds_read_b64_tr_b16 a[30:31], v34 offset:832
    v_mfma_f32_4x4x4_16b_bf16 a[52:55], a[112:113], a[6:7], a[52:55]
    s_waitcnt lgkmcnt(10)
    v_mfma_f32_4x4x4_16b_bf16 a[56:59], a[112:113], a[8:9], a[56:59]
    v_mfma_f32_32x32x16_bf16 v[112:127], a[8:11], v[56:59], v[112:127]
    ds_read_b64_tr_b16 a[32:33], v34 offset:128
    ds_read_b64_tr_b16 a[34:35], v34 offset:896
    v_mfma_f32_4x4x4_16b_bf16 a[56:59], a[112:113], a[10:11], a[56:59]
    s_waitcnt lgkmcnt(10)
    v_mfma_f32_32x32x16_bf16 v[80:95], a[12:15], v[60:63], v[80:95]
    ds_read_b64_tr_b16 a[36:37], v35 offset:0
    ds_read_b64_tr_b16 a[38:39], v35 offset:768
    s_waitcnt lgkmcnt(10)
    v_mfma_f32_32x32x16_bf16 v[96:111], a[16:19], v[60:63], v[96:111]
    ds_read_b64_tr_b16 a[40:41], v35 offset:64
    ds_read_b64_tr_b16 a[42:43], v35 offset:832
    s_waitcnt lgkmcnt(10)
    v_mfma_f32_32x32x16_bf16 v[112:127], a[20:23], v[60:63], v[112:127]
    ds_read_b64_tr_b16 a[44:45], v35 offset:128
    ds_read_b64_tr_b16 a[46:47], v35 offset:896
    s_barrier
    ds_read_b128 a[96:99], v36 offset:8192
    ds_read_b128 a[100:103], v37 offset:8192
    ds_read_b128 a[104:107], v38 offset:8192
    ds_read_b128 a[108:111], v39 offset:8192
    s_waitcnt lgkmcnt(14)
    v_mfma_f32_32x32x16_bf16 v[80:95], a[24:27], v[64:67], v[80:95]
    ds_read_b64_tr_b16 a[0:1], v32 offset:12288
    ds_read_b64_tr_b16 a[2:3], v32 offset:13056
    s_waitcnt lgkmcnt(14)
    v_mfma_f32_32x32x16_bf16 v[96:111], a[28:31], v[64:67], v[96:111]
    ds_read_b64_tr_b16 a[4:5], v32 offset:12352
    ds_read_b64_tr_b16 a[6:7], v32 offset:13120
    s_waitcnt lgkmcnt(14)
    v_mfma_f32_32x32x16_bf16 v[112:127], a[32:35], v[64:67], v[112:127]
    ds_read_b64_tr_b16 a[8:9], v32 offset:12416
    ds_read_b64_tr_b16 a[10:11], v32 offset:13184
    s_waitcnt lgkmcnt(14)
    v_mfma_f32_32x32x16_bf16 v[80:95], a[36:39], v[68:71], v[80:95]
    ds_read_b64_tr_b16 a[12:13], v33 offset:12288
    ds_read_b64_tr_b16 a[14:15], v33 offset:13056
    s_waitcnt lgkmcnt(14)
    v_mfma_f32_32x32x16_bf16 v[96:111], a[40:43], v[68:71], v[96:111]
    ds_read_b64_tr_b16 a[16:17], v33 offset:12352
    ds_read_b64_tr_b16 a[18:19], v33 offset:13120
    s_waitcnt lgkmcnt(14)
    v_mfma_f32_32x32x16_bf16 v[112:127], a[44:47], v[68:71], v[112:127]
    ds_read_b64_tr_b16 a[20:21], v33 offset:12416
    ds_read_b64_tr_b16 a[22:23], v33 offset:13184
    s_waitcnt lgkmcnt(10)
    v_mfma_f32_4x4x4_16b_bf16 a[48:51], a[112:113], a[0:1], a[48:51]
    v_mfma_f32_32x32x16_bf16 v[80:95], a[0:3], a[96:99], v[80:95]
    ds_read_b64_tr_b16 a[24:25], v34 offset:12288
    ds_read_b64_tr_b16 a[26:27], v34 offset:13056
    v_mfma_f32_4x4x4_16b_bf16 a[48:51], a[112:113], a[2:3], a[48:51]
    buffer_load_dwordx4 v[72:75], v41, s[32:35], 0 offen sc1
    s_waitcnt lgkmcnt(10)
    v_mfma_f32_4x4x4_16b_bf16 a[52:55], a[112:113], a[4:5], a[52:55]
    v_mfma_f32_32x32x16_bf16 v[96:111], a[4:7], a[96:99], v[96:111]
    ds_read_b64_tr_b16 a[28:29], v34 offset:12352
    ds_read_b64_tr_b16 a[30:31], v34 offset:13120
    v_mfma_f32_4x4x4_16b_bf16 a[52:55], a[112:113], a[6:7], a[52:55]
    s_waitcnt lgkmcnt(10)
    v_mfma_f32_4x4x4_16b_bf16 a[56:59], a[112:113], a[8:9], a[56:59]
    v_mfma_f32_32x32x16_bf16 v[112:127], a[8:11], a[96:99], v[112:127]
    ds_read_b64_tr_b16 a[32:33], v34 offset:12416
    ds_read_b64_tr_b16 a[34:35], v34 offset:13184
    v_mfma_f32_4x4x4_16b_bf16 a[56:59], a[112:113], a[10:11], a[56:59]
    s_waitcnt lgkmcnt(10)
    v_mfma_f32_32x32x16_bf16 v[80:95], a[12:15], a[100:103], v[80:95]
    ds_read_b64_tr_b16 a[36:37], v35 offset:12288
    ds_read_b64_tr_b16 a[38:39], v35 offset:13056
    s_waitcnt lgkmcnt(10)
    v_mfma_f32_32x32x16_bf16 v[96:111], a[16:19], a[100:103], v[96:111]
    ds_read_b64_tr_b16 a[40:41], v35 offset:12352
    ds_read_b64_tr_b16 a[42:43], v35 offset:13120
    s_waitcnt lgkmcnt(10)
    v_mfma_f32_32x32x16_bf16 v[112:127], a[20:23], a[100:103], v[112:127]
    ds_read_b64_tr_b16 a[44:45], v35 offset:12416
    ds_read_b64_tr_b16 a[46:47], v35 offset:13184
    s_barrier
    ds_read_b128 v[56:59], v36 offset:12288
    ds_read_b128 v[60:63], v37 offset:12288
    ds_read_b128 v[64:67], v38 offset:12288
    ds_read_b128 v[68:71], v39 offset:12288
    s_waitcnt lgkmcnt(14)
    v_mfma_f32_32x32x16_bf16 v[80:95], a[24:27], a[104:107], v[80:95]
    ds_read_b64_tr_b16 a[0:1], v32 offset:24576
    ds_read_b64_tr_b16 a[2:3], v32 offset:25344
    s_waitcnt lgkmcnt(14)
    v_mfma_f32_32x32x16_bf16 v[96:111], a[28:31], a[104:107], v[96:111]
    ds_read_b64_tr_b16 a[4:5], v32 offset:24640
    ds_read_b64_tr_b16 a[6:7], v32 offset:25408
    s_waitcnt lgkmcnt(14)
    v_mfma_f32_32x32x16_bf16 v[112:127], a[32:35], a[104:107], v[112:127]
    ds_read_b64_tr_b16 a[8:9], v32 offset:24704
    ds_read_b64_tr_b16 a[10:11], v32 offset:25472
    s_waitcnt lgkmcnt(14)
    v_mfma_f32_32x32x16_bf16 v[80:95], a[36:39], a[108:111], v[80:95]
    ds_read_b64_tr_b16 a[12:13], v33 offset:24576
    ds_read_b64_tr_b16 a[14:15], v33 offset:25344
    s_waitcnt lgkmcnt(14)
    v_mfma_f32_32x32x16_bf16 v[96:111], a[40:43], a[108:111], v[96:111]
    ds_read_b64_tr_b16 a[16:17], v33 offset:24640
    ds_read_b64_tr_b16 a[18:19], v33 offset:25408
    s_waitcnt lgkmcnt(14)
    v_mfma_f32_32x32x16_bf16 v[112:127], a[44:47], a[108:111], v[112:127]
    ds_read_b64_tr_b16 a[20:21], v33 offset:24704
    ds_read_b64_tr_b16 a[22:23], v33 offset:25472
    s_waitcnt lgkmcnt(10)
    v_mfma_f32_4x4x4_16b_bf16 a[48:51], a[112:113], a[0:1], a[48:51]
    v_mfma_f32_32x32x16_bf16 v[80:95], a[0:3], v[56:59], v[80:95]
    ds_read_b64_tr_b16 a[24:25], v34 offset:24576
    ds_read_b64_tr_b16 a[26:27], v34 offset:25344
    v_mfma_f32_4x4x4_16b_bf16 a[48:51], a[112:113], a[2:3], a[48:51]
    s_waitcnt lgkmcnt(10)
    v_mfma_f32_4x4x4_16b_bf16 a[52:55], a[112:113], a[4:5], a[52:55]
    v_mfma_f32_32x32x16_bf16 v[96:111], a[4:7], v[56:59], v[96:111]
    ds_read_b64_tr_b16 a[28:29], v34 offset:24640
    ds_read_b64_tr_b16 a[30:31], v34 offset:25408
    v_mfma_f32_4x4x4_16b_bf16 a[52:55], a[112:113], a[6:7], a[52:55]
    s_waitcnt lgkmcnt(10)
    v_mfma_f32_4x4x4_16b_bf16 a[56:59], a[112:113], a[8:9], a[56:59]
    v_mfma_f32_32x32x16_bf16 v[112:127], a[8:11], v[56:59], v[112:127]
    ds_read_b64_tr_b16 a[32:33], v34 offset:24704
    ds_read_b64_tr_b16 a[34:35], v34 offset:25472
    v_mfma_f32_4x4x4_16b_bf16 a[56:59], a[112:113], a[10:11], a[56:59]
    s_waitcnt lgkmcnt(10)
    v_mfma_f32_32x32x16_bf16 v[80:95], a[12:15], v[60:63], v[80:95]
    ds_read_b64_tr_b16 a[36:37], v35 offset:24576
    ds_read_b64_tr_b16 a[38:39], v35 offset:25344
    s_waitcnt lgkmcnt(10)
    v_mfma_f32_32x32x16_bf16 v[96:111], a[16:19], v[60:63], v[96:111]
    ds_read_b64_tr_b16 a[40:41], v35 offset:24640
    ds_read_b64_tr_b16 a[42:43], v35 offset:25408
    s_waitcnt lgkmcnt(10)
    v_mfma_f32_32x32x16_bf16 v[112:127], a[20:23], v[60:63], v[112:127]
    ds_read_b64_tr_b16 a[44:45], v35 offset:24704
    ds_read_b64_tr_b16 a[46:47], v35 offset:25472
    s_barrier
    ds_read_b128 a[96:99], v36 offset:16384
    ds_read_b128 a[100:103], v37 offset:16384
    ds_read_b128 a[104:107], v38 offset:16384
    ds_read_b128 a[108:111], v39 offset:16384
    s_waitcnt lgkmcnt(14)
    v_mfma_f32_32x32x16_bf16 v[80:95], a[24:27], v[64:67], v[80:95]
    ds_read_b64_tr_b16 a[0:1], v32 offset:36864
    ds_read_b64_tr_b16 a[2:3], v32 offset:37632
    s_waitcnt lgkmcnt(14)
    v_mfma_f32_32x32x16_bf16 v[96:111], a[28:31], v[64:67], v[96:111]
    ds_read_b64_tr_b16 a[4:5], v32 offset:36928
    ds_read_b64_tr_b16 a[6:7], v32 offset:37696
    s_waitcnt lgkmcnt(14)
    v_mfma_f32_32x32x16_bf16 v[112:127], a[32:35], v[64:67], v[112:127]
    ds_read_b64_tr_b16 a[8:9], v32 offset:36992
    ds_read_b64_tr_b16 a[10:11], v32 offset:37760
    s_waitcnt lgkmcnt(14)
    v_mfma_f32_32x32x16_bf16 v[80:95], a[36:39], v[68:71], v[80:95]
    ds_read_b64_tr_b16 a[12:13], v33 offset:36864
    ds_read_b64_tr_b16 a[14:15], v33 offset:37632
    s_waitcnt lgkmcnt(14)
    v_mfma_f32_32x32x16_bf16 v[96:111], a[40:43], v[68:71], v[96:111]
    ds_read_b64_tr_b16 a[16:17], v33 offset:36928
    ds_read_b64_tr_b16 a[18:19], v33 offset:37696
    s_waitcnt lgkmcnt(14)
    v_mfma_f32_32x32x16_bf16 v[112:127], a[44:47], v[68:71], v[112:127]
    ds_read_b64_tr_b16 a[20:21], v33 offset:36992
    ds_read_b64_tr_b16 a[22:23], v33 offset:37760
    s_waitcnt lgkmcnt(10)
    v_mfma_f32_4x4x4_16b_bf16 a[48:51], a[112:113], a[0:1], a[48:51]
    v_mfma_f32_32x32x16_bf16 v[80:95], a[0:3], a[96:99], v[80:95]
    ds_read_b64_tr_b16 a[24:25], v34 offset:36864
    ds_read_b64_tr_b16 a[26:27], v34 offset:37632
    v_mfma_f32_4x4x4_16b_bf16 a[48:51], a[112:113], a[2:3], a[48:51]
    s_waitcnt vmcnt(0)
    v_xor_b32 v8, s45, v72
    v_xor_b32 v9, s45, v75
    v_or_b32 v8, v8, v9
    v_cmp_eq_u32 vcc, 0, v8
    s_nop 1
    s_cmp_eq_u64 vcc, -1
    s_cbranch_scc1 L_ok9
    s_mov_b32 s49, 60000
L_retry10:
    s_sub_u32 s49, s49, 1
    s_cmp_eq_u32 s49, 0
    s_cbranch_scc1 L_ok9
    buffer_load_dwordx4 v[72:75], v41, s[32:35], 0 offen sc1
    s_waitcnt vmcnt(0)
    v_xor_b32 v8, s45, v72
    v_xor_b32 v9, s45, v75
    v_or_b32 v8, v8, v9
    v_cmp_eq_u32 vcc, 0, v8
    s_nop 1
    s_cmp_eq_u64 vcc, -1
    s_cbranch_scc0 L_retry10
L_ok9:
    v_and_b32 v26, 1, v1
    v_cmp_eq_u32 vcc, 1, v26
    s_nop 1
    v_cndmask_b32 v26, v73, v74, vcc
    v_xor_b32 v26, 0x8000, v26
    v_and_b32 v52, 0xffff0000, v26
    v_rcp_f32 v52, v52
    v_and_b32 v27, 0xffff, v26
    v_lshl_or_b32 v27, v27, 16, v27
    v_cmp_gt_u32 vcc, 32, v1
    v_mov_b32 v53, v52
    s_nop 0
    v_cndmask_b32 v76, 0, v27, vcc
    v_cndmask_b32 v77, 0, v26, vcc
    s_waitcnt lgkmcnt(10)
    v_mfma_f32_4x4x4_16b_bf16 a[52:55], a[112:113], a[4:5], a[52:55]
    v_mfma_f32_32x32x16_bf16 v[96:111], a[4:7], a[96:99], v[96:111]
    ds_read_b64_tr_b16 a[28:29], v34 offset:36928
    ds_read_b64_tr_b16 a[30:31], v34 offset:37696
    v_mfma_f32_4x4x4_16b_bf16 a[52:55], a[112:113], a[6:7], a[52:55]
    s_waitcnt lgkmcnt(10)
    v_mfma_f32_4x4x4_16b_bf16 a[56:59], a[112:113], a[8:9], a[56:59]
    v_mfma_f32_32x32x16_bf16 v[112:127], a[8:11], a[96:99], v[112:127]
    ds_read_b64_tr_b16 a[32:33], v34 offset:36992
    ds_read_b64_tr_b16 a[34:35], v34 offset:37760
    v_mfma_f32_4x4x4_16b_bf16 a[56:59], a[112:113], a[10:11], a[56:59]
    s_waitcnt lgkmcnt(10)
    v_mfma_f32_32x32x16_bf16 v[80:95], a[12:15], a[100:103], v[80:95]
    ds_read_b64_tr_b16 a[36:37], v35 offset:36864
    ds_read_b64_tr_b16 a[38:39], v35 offset:37632
    buffer_load_dwordx2 v[8:9], v45, s[32:35], 0 offen sc1
    s_waitcnt lgkmcnt(10)
    v_mfma_f32_32x32x16_bf16 v[96:111], a[16:19], a[100:103], v[96:111]
    ds_read_b64_tr_b16 a[40:41], v35 offset:36928
    ds_read_b64_tr_b16 a[42:43], v35 offset:37696
    s_waitcnt lgkmcnt(10)
    v_mfma_f32_32x32x16_bf16 v[112:127], a[20:23], a[100:103], v[112:127]
    ds_read_b64_tr_b16 a[44:45], v35 offset:36992
    ds_read_b64_tr_b16 a[46:47], v35 offset:37760
    s_nop 5
    s_lshl_b32 s46, s36, 3
    s_add_u32 s46, s46, 155648
    v_lshl_add_u32 v20, v4, 5, s46
    v_lshl_add_u32 v20, v3, 2, v20
    ds_write_b32 v20, a48 offset:0
    ds_write_b32 v20, a52 offset:1024
    ds_write_b32 v20, a56 offset:2048
    s_waitcnt lgkmcnt(13)
    v_mfma_f32_32x32x16_bf16 v[80:95], a[24:27], a[104:107], v[80:95]
    s_waitcnt lgkmcnt(11)
    v_mfma_f32_32x32x16_bf16 v[96:111], a[28:31], a[104:107], v[96:111]
    s_waitcnt lgkmcnt(9)
    v_mfma_f32_32x32x16_bf16 v[112:127], a[32:35], a[104:107], v[112:127]
    s_waitcnt lgkmcnt(0)
    s_barrier
    v_lshlrev_b32 v20, 5, v4
    v_lshl_add_u32 v20, v3, 4, v20
    v_add_u32 v20, 155648, v20
    ds_read_b128 v[56:59], v20 offset:0
    ds_read_b128 v[60:63], v20 offset:1024
    ds_read_b128 v[64:67], v20 offset:2048
    v_mfma_f32_32x32x16_bf16 v[80:95], a[36:39], a[108:111], v[80:95]
    v_mfma_f32_32x32x16_bf16 v[96:111], a[40:43], a[108:111], v[96:111]
    v_mfma_f32_32x32x16_bf16 v[112:127], a[44:47], a[108:111], v[112:127]
    s_waitcnt lgkmcnt(0)
    v_add_f32 v56, v56, v57
    v_add_f32 v58, v58, v59
    v_add_f32 v56, v56, v58
    v_mov_b32 v57, v56
    s_nop 1
    v_permlane32_swap_b32 v56, v57
    s_nop 1
    v_add_f32 v56, v56, v57
    v_and_b32 v57, 0xffff0000, v56
    v_sub_f32 v56, v56, v57
    v_and_b32 v58, 0xffff0000, v56
    v_sub_f32 v56, v56, v58
    v_lshrrev_b32 v57, 16, v57
    v_or_b32 v12, v57, v58
    v_lshrrev_b32 v56, 16, v56
    v_lshl_or_b32 v13, v42, 16, v56
    v_mov_b32 v14, 0
    v_mov_b32 v15, 0
    s_nop 1
    v_mfma_f32_32x32x16_bf16 v[80:95], v[12:15], v[76:79], v[80:95]
    v_add_f32 v60, v60, v61
    v_add_f32 v62, v62, v63
    v_add_f32 v60, v60, v62
    v_mov_b32 v61, v60
    s_nop 1
    v_permlane32_swap_b32 v60, v61
    s_nop 1
    v_add_f32 v60, v60, v61
    v_and_b32 v61, 0xffff0000, v60
    v_sub_f32 v60, v60, v61
    v_and_b32 v62, 0xffff0000, v60
    v_sub_f32 v60, v60, v62
    v_lshrrev_b32 v61, 16, v61
    v_or_b32 v16, v61, v62
    v_lshrrev_b32 v60, 16, v60
    v_lshl_or_b32 v17, v43, 16, v60
    v_mov_b32 v18, 0
    v_mov_b32 v19, 0
    s_nop 1
    v_mfma_f32_32x32x16_bf16 v[96:111], v[16:19], v[76:79], v[96:111]
    v_add_f32 v64, v64, v65
    v_add_f32 v66, v66, v67
    v_add_f32 v64, v64, v66
    v_mov_b32 v65, v64
    s_nop 1
    v_permlane32_swap_b32 v64, v65
    s_nop 1
    v_add_f32 v64, v64, v65
    v_and_b32 v65, 0xffff0000, v64
    v_sub_f32 v64, v64, v65
    v_and_b32 v66, 0xffff0000, v64
    v_sub_f32 v64, v64, v66
    v_lshrrev_b32 v65, 16, v65
    v_or_b32 v20, v65, v66
    v_lshrrev_b32 v64, 16, v64
    v_lshl_or_b32 v21, v44, 16, v64
    v_mov_b32 v22, 0
    v_mov_b32 v23, 0
    s_nop 1
    v_mfma_f32_32x32x16_bf16 v[112:127], v[20:23], v[76:79], v[112:127]
    v_pk_mul_f32 v[80:81], v[80:81], v[52:53]
    v_pk_mul_f32 v[82:83], v[82:83], v[52:53]
    v_pk_mul_f32 v[84:85], v[84:85], v[52:53]
    v_pk_mul_f32 v[86:87], v[86:87], v[52:53]
    v_pk_mul_f32 v[56:57], v[80:81], v[80:81]
    v_pk_mul_f32 v[58:59], v[82:83], v[82:83]
    v_pk_mul_f32 v[60:61], v[84:85], v[84:85]
    v_pk_mul_f32 v[62:63], v[86:87], v[86:87]
    v_pk_fma_f32 v[56:57], v[56:57], v[46:47], v[48:49]
    v_pk_fma_f32 v[58:59], v[58:59], v[46:47], v[48:49]
    v_pk_fma_f32 v[60:61], v[60:61], v[46:47], v[48:49]
    v_pk_fma_f32 v[62:63], v[62:63], v[46:47], v[48:49]
    v_pk_mul_f32 v[56:57], v[56:57], v[80:81]
    v_pk_mul_f32 v[58:59], v[58:59], v[82:83]
    v_pk_mul_f32 v[60:61], v[60:61], v[84:85]
    v_pk_mul_f32 v[62:63], v[62:63], v[86:87]
    v_exp_f32 v56, v56
    v_exp_f32 v57, v57
    v_exp_f32 v58, v58
    v_exp_f32 v59, v59
    v_exp_f32 v60, v60
    v_exp_f32 v61, v61
    v_exp_f32 v62, v62
    v_exp_f32 v63, v63
    v_pk_add_f32 v[56:57], v[56:57], v[50:51]
    v_pk_add_f32 v[58:59], v[58:59], v[50:51]
    v_pk_add_f32 v[60:61], v[60:61], v[50:51]
    v_pk_add_f32 v[62:63], v[62:63], v[50:51]
    v_rcp_f32 v56, v56
    v_rcp_f32 v57, v57
    v_rcp_f32 v58, v58
    v_rcp_f32 v59, v59
    v_rcp_f32 v60, v60
    v_rcp_f32 v61, v61
    v_rcp_f32 v62, v62
    v_rcp_f32 v63, v63
    v_pk_mul_f32 v[56:57], v[56:57], v[80:81]
    v_pk_mul_f32 v[58:59], v[58:59], v[82:83]
    v_pk_mul_f32 v[60:61], v[60:61], v[84:85]
    v_pk_mul_f32 v[62:63], v[62:63], v[86:87]
    v_cvt_pk_bf16_f32 v80, v56, v57
    v_cvt_pk_bf16_f32 v81, v58, v59
    v_cvt_pk_bf16_f32 v82, v60, v61
    v_cvt_pk_bf16_f32 v83, v62, v63
    buffer_store_dwordx4 v[80:83], v40, s[32:35], s58 offen offset:0 sc1
    v_pk_mul_f32 v[88:89], v[88:89], v[52:53]
    v_pk_mul_f32 v[90:91], v[90:91], v[52:53]
    v_pk_mul_f32 v[92:93], v[92:93], v[52:53]
    v_pk_mul_f32 v[94:95], v[94:95], v[52:53]
    v_pk_mul_f32 v[64:65], v[88:89], v[88:89]
    v_pk_mul_f32 v[66:67], v[90:91], v[90:91]
    v_pk_mul_f32 v[68:69], v[92:93], v[92:93]
    v_pk_mul_f32 v[70:71], v[94:95], v[94:95]
    v_pk_fma_f32 v[64:65], v[64:65], v[46:47], v[48:49]
    v_pk_fma_f32 v[66:67], v[66:67], v[46:47], v[48:49]
    v_pk_fma_f32 v[68:69], v[68:69], v[46:47], v[48:49]
    v_pk_fma_f32 v[70:71], v[70:71], v[46:47], v[48:49]
    v_pk_mul_f32 v[64:65], v[64:65], v[88:89]
    v_pk_mul_f32 v[66:67], v[66:67], v[90:91]
    v_pk_mul_f32 v[68:69], v[68:69], v[92:93]
    v_pk_mul_f32 v[70:71], v[70:71], v[94:95]
    v_exp_f32 v64, v64
    v_exp_f32 v65, v65
    v_exp_f32 v66, v66
    v_exp_f32 v67, v67
    v_exp_f32 v68, v68
    v_exp_f32 v69, v69
    v_exp_f32 v70, v70
    v_exp_f32 v71, v71
    v_pk_add_f32 v[64:65], v[64:65], v[50:51]
    v_pk_add_f32 v[66:67], v[66:67], v[50:51]
    v_pk_add_f32 v[68:69], v[68:69], v[50:51]
    v_pk_add_f32 v[70:71], v[70:71], v[50:51]
    v_rcp_f32 v64, v64
    v_rcp_f32 v65, v65
    v_rcp_f32 v66, v66
    v_rcp_f32 v67, v67
    v_rcp_f32 v68, v68
    v_rcp_f32 v69, v69
    v_rcp_f32 v70, v70
    v_rcp_f32 v71, v71
    v_pk_mul_f32 v[64:65], v[64:65], v[88:89]
    v_pk_mul_f32 v[66:67], v[66:67], v[90:91]
    v_pk_mul_f32 v[68:69], v[68:69], v[92:93]
    v_pk_mul_f32 v[70:71], v[70:71], v[94:95]
    v_cvt_pk_bf16_f32 v88, v64, v65
    v_cvt_pk_bf16_f32 v89, v66, v67
    v_cvt_pk_bf16_f32 v90, v68, v69
    v_cvt_pk_bf16_f32 v91, v70, v71
    buffer_store_dwordx4 v[88:91], v40, s[32:35], s58 offen offset:512 sc1
    v_pk_mul_f32 v[96:97], v[96:97], v[52:53]
    v_pk_mul_f32 v[98:99], v[98:99], v[52:53]
    v_pk_mul_f32 v[100:101], v[100:101], v[52:53]
    v_pk_mul_f32 v[102:103], v[102:103], v[52:53]
    v_pk_mul_f32 v[56:57], v[96:97], v[96:97]
    v_pk_mul_f32 v[58:59], v[98:99], v[98:99]
    v_pk_mul_f32 v[60:61], v[100:101], v[100:101]
    v_pk_mul_f32 v[62:63], v[102:103], v[102:103]
    v_pk_fma_f32 v[56:57], v[56:57], v[46:47], v[48:49]
    v_pk_fma_f32 v[58:59], v[58:59], v[46:47], v[48:49]
    v_pk_fma_f32 v[60:61], v[60:61], v[46:47], v[48:49]
    v_pk_fma_f32 v[62:63], v[62:63], v[46:47], v[48:49]
    v_pk_mul_f32 v[56:57], v[56:57], v[96:97]
    v_pk_mul_f32 v[58:59], v[58:59], v[98:99]
    v_pk_mul_f32 v[60:61], v[60:61], v[100:101]
    v_pk_mul_f32 v[62:63], v[62:63], v[102:103]
    v_exp_f32 v56, v56
    v_exp_f32 v57, v57
    v_exp_f32 v58, v58
    v_exp_f32 v59, v59
    v_exp_f32 v60, v60
    v_exp_f32 v61, v61
    v_exp_f32 v62, v62
    v_exp_f32 v63, v63
    v_pk_add_f32 v[56:57], v[56:57], v[50:51]
    v_pk_add_f32 v[58:59], v[58:59], v[50:51]
    v_pk_add_f32 v[60:61], v[60:61], v[50:51]
    v_pk_add_f32 v[62:63], v[62:63], v[50:51]
    v_rcp_f32 v56, v56
    v_rcp_f32 v57, v57
    v_rcp_f32 v58, v58
    v_rcp_f32 v59, v59
    v_rcp_f32 v60, v60
    v_rcp_f32 v61, v61
    v_rcp_f32 v62, v62
    v_rcp_f32 v63, v63
    v_pk_mul_f32 v[56:57], v[56:57], v[96:97]
    v_pk_mul_f32 v[58:59], v[58:59], v[98:99]
    v_pk_mul_f32 v[60:61], v[60:61], v[100:101]
    v_pk_mul_f32 v[62:63], v[62:63], v[102:103]
    v_cvt_pk_bf16_f32 v96, v56, v57
    v_cvt_pk_bf16_f32 v97, v58, v59
    v_cvt_pk_bf16_f32 v98, v60, v61
    v_cvt_pk_bf16_f32 v99, v62, v63
    buffer_store_dwordx4 v[96:99], v40, s[32:35], s58 offen offset:1024 sc1
    v_pk_mul_f32 v[104:105], v[104:105], v[52:53]
    v_pk_mul_f32 v[106:107], v[106:107], v[52:53]
    v_pk_mul_f32 v[108:109], v[108:109], v[52:53]
    v_pk_mul_f32 v[110:111], v[110:111], v[52:53]
    v_pk_mul_f32 v[64:65], v[104:105], v[104:105]
    v_pk_mul_f32 v[66:67], v[106:107], v[106:107]
    v_pk_mul_f32 v[68:69], v[108:109], v[108:109]
    v_pk_mul_f32 v[70:71], v[110:111], v[110:111]
    v_pk_fma_f32 v[64:65], v[64:65], v[46:47], v[48:49]
    v_pk_fma_f32 v[66:67], v[66:67], v[46:47], v[48:49]
    v_pk_fma_f32 v[68:69], v[68:69], v[46:47], v[48:49]
    v_pk_fma_f32 v[70:71], v[70:71], v[46:47], v[48:49]
    v_pk_mul_f32 v[64:65], v[64:65], v[104:105]
    v_pk_mul_f32 v[66:67], v[66:67], v[106:107]
    v_pk_mul_f32 v[68:69], v[68:69], v[108:109]
    v_pk_mul_f32 v[70:71], v[70:71], v[110:111]
    v_exp_f32 v64, v64
    v_exp_f32 v65, v65
    v_exp_f32 v66, v66
    v_exp_f32 v67, v67
    v_exp_f32 v68, v68
    v_exp_f32 v69, v69
    v_exp_f32 v70, v70
    v_exp_f32 v71, v71
    v_pk_add_f32 v[64:65], v[64:65], v[50:51]
    v_pk_add_f32 v[66:67], v[66:67], v[50:51]
    v_pk_add_f32 v[68:69], v[68:69], v[50:51]
    v_pk_add_f32 v[70:71], v[70:71], v[50:51]
    v_rcp_f32 v64, v64
    v_rcp_f32 v65, v65
    v_rcp_f32 v66, v66
    v_rcp_f32 v67, v67
    v_rcp_f32 v68, v68
    v_rcp_f32 v69, v69
    v_rcp_f32 v70, v70
    v_rcp_f32 v71, v71
    v_pk_mul_f32 v[64:65], v[64:65], v[104:105]
    v_pk_mul_f32 v[66:67], v[66:67], v[106:107]
    v_pk_mul_f32 v[68:69], v[68:69], v[108:109]
    v_pk_mul_f32 v[70:71], v[70:71], v[110:111]
    v_cvt_pk_bf16_f32 v104, v64, v65
    v_cvt_pk_bf16_f32 v105, v66, v67
    v_cvt_pk_bf16_f32 v106, v68, v69
    v_cvt_pk_bf16_f32 v107, v70, v71
    buffer_store_dwordx4 v[104:107], v40, s[32:35], s58 offen offset:1536 sc1
    v_pk_mul_f32 v[112:113], v[112:113], v[52:53]
    v_pk_mul_f32 v[114:115], v[114:115], v[52:53]
    v_pk_mul_f32 v[116:117], v[116:117], v[52:53]
    v_pk_mul_f32 v[118:119], v[118:119], v[52:53]
    v_pk_mul_f32 v[56:57], v[112:113], v[112:113]
    v_pk_mul_f32 v[58:59], v[114:115], v[114:115]
    v_pk_mul_f32 v[60:61], v[116:117], v[116:117]
    v_pk_mul_f32 v[62:63], v[118:119], v[118:119]
    v_pk_fma_f32 v[56:57], v[56:57], v[46:47], v[48:49]
    v_pk_fma_f32 v[58:59], v[58:59], v[46:47], v[48:49]
    v_pk_fma_f32 v[60:61], v[60:61], v[46:47], v[48:49]
    v_pk_fma_f32 v[62:63], v[62:63], v[46:47], v[48:49]
    v_pk_mul_f32 v[56:57], v[56:57], v[112:113]
    v_pk_mul_f32 v[58:59], v[58:59], v[114:115]
    v_pk_mul_f32 v[60:61], v[60:61], v[116:117]
    v_pk_mul_f32 v[62:63], v[62:63], v[118:119]
    v_exp_f32 v56, v56
    v_exp_f32 v57, v57
    v_exp_f32 v58, v58
    v_exp_f32 v59, v59
    v_exp_f32 v60, v60
    v_exp_f32 v61, v61
    v_exp_f32 v62, v62
    v_exp_f32 v63, v63
    v_pk_add_f32 v[56:57], v[56:57], v[50:51]
    v_pk_add_f32 v[58:59], v[58:59], v[50:51]
    v_pk_add_f32 v[60:61], v[60:61], v[50:51]
    v_pk_add_f32 v[62:63], v[62:63], v[50:51]
    v_rcp_f32 v56, v56
    v_rcp_f32 v57, v57
    v_rcp_f32 v58, v58
    v_rcp_f32 v59, v59
    v_rcp_f32 v60, v60
    v_rcp_f32 v61, v61
    v_rcp_f32 v62, v62
    v_rcp_f32 v63, v63
    v_pk_mul_f32 v[56:57], v[56:57], v[112:113]
    v_pk_mul_f32 v[58:59], v[58:59], v[114:115]
    v_pk_mul_f32 v[60:61], v[60:61], v[116:117]
    v_pk_mul_f32 v[62:63], v[62:63], v[118:119]
    v_cvt_pk_bf16_f32 v112, v56, v57
    v_cvt_pk_bf16_f32 v113, v58, v59
    v_cvt_pk_bf16_f32 v114, v60, v61
    v_cvt_pk_bf16_f32 v115, v62, v63
    buffer_store_dwordx4 v[112:115], v40, s[32:35], s58 offen offset:2048 sc1
    v_pk_mul_f32 v[120:121], v[120:121], v[52:53]
    v_pk_mul_f32 v[122:123], v[122:123], v[52:53]
    v_pk_mul_f32 v[124:125], v[124:125], v[52:53]
    v_pk_mul_f32 v[126:127], v[126:127], v[52:53]
    v_pk_mul_f32 v[64:65], v[120:121], v[120:121]
    v_pk_mul_f32 v[66:67], v[122:123], v[122:123]
    v_pk_mul_f32 v[68:69], v[124:125], v[124:125]
    v_pk_mul_f32 v[70:71], v[126:127], v[126:127]
    v_pk_fma_f32 v[64:65], v[64:65], v[46:47], v[48:49]
    v_pk_fma_f32 v[66:67], v[66:67], v[46:47], v[48:49]
    v_pk_fma_f32 v[68:69], v[68:69], v[46:47], v[48:49]
    v_pk_fma_f32 v[70:71], v[70:71], v[46:47], v[48:49]
    v_pk_mul_f32 v[64:65], v[64:65], v[120:121]
    v_pk_mul_f32 v[66:67], v[66:67], v[122:123]
    v_pk_mul_f32 v[68:69], v[68:69], v[124:125]
    v_pk_mul_f32 v[70:71], v[70:71], v[126:127]
    v_exp_f32 v64, v64
    v_exp_f32 v65, v65
    v_exp_f32 v66, v66
    v_exp_f32 v67, v67
    v_exp_f32 v68, v68
    v_exp_f32 v69, v69
    v_exp_f32 v70, v70
    v_exp_f32 v71, v71
    v_pk_add_f32 v[64:65], v[64:65], v[50:51]
    v_pk_add_f32 v[66:67], v[66:67], v[50:51]
    v_pk_add_f32 v[68:69], v[68:69], v[50:51]
    v_pk_add_f32 v[70:71], v[70:71], v[50:51]
    v_rcp_f32 v64, v64
    v_rcp_f32 v65, v65
    v_rcp_f32 v66, v66
    v_rcp_f32 v67, v67
    v_rcp_f32 v68, v68
    v_rcp_f32 v69, v69
    v_rcp_f32 v70, v70
    v_rcp_f32 v71, v71
    v_pk_mul_f32 v[64:65], v[64:65], v[120:121]
    v_pk_mul_f32 v[66:67], v[66:67], v[122:123]
    v_pk_mul_f32 v[68:69], v[68:69], v[124:125]
    v_pk_mul_f32 v[70:71], v[70:71], v[126:127]
    v_cvt_pk_bf16_f32 v120, v64, v65
    v_cvt_pk_bf16_f32 v121, v66, v67
    v_cvt_pk_bf16_f32 v122, v68, v69
    v_cvt_pk_bf16_f32 v123, v70, v71
    buffer_store_dwordx4 v[120:123], v40, s[32:35], s58 offen offset:2560 sc1
    s_waitcnt vmcnt(6)
    s_or_b32 s46, s45, 1
    v_xor_b32 v8, s46, v8
    v_xor_b32 v9, s46, v9
    v_or_b32 v8, v8, v9
    v_and_b32 v8, 0xfffffffd, v8
    v_cmp_eq_u32 vcc, 0, v8
    s_nop 1
    s_cmp_eq_u64 vcc, -1
    s_cbranch_scc1 L_ok11
    s_mov_b32 s49, 60000
L_retry12:
    s_sub_u32 s49, s49, 1
    s_cmp_eq_u32 s49, 0
    s_cbranch_scc1 L_ok11
    buffer_load_dwordx2 v[8:9], v45, s[32:35], 0 offen sc1
    s_waitcnt vmcnt(0)
    s_or_b32 s46, s45, 1
    v_xor_b32 v8, s46, v8
    v_xor_b32 v9, s46, v9
    v_or_b32 v8, v8, v9
    v_and_b32 v8, 0xfffffffd, v8
    v_cmp_eq_u32 vcc, 0, v8
    s_nop 1
    s_cmp_eq_u64 vcc, -1
    s_cbranch_scc0 L_retry12
L_ok11:
    buffer_load_dwordx4 a[0:3], v2, s[32:35], s76 offen offset:0 sc1
    buffer_load_dwordx4 a[4:7], v2, s[32:35], s76 offen offset:1024 sc1
    buffer_load_dwordx4 a[8:11], v2, s[32:35], s76 offen offset:2048 sc1
    buffer_load_dwordx4 a[12:15], v2, s[32:35], s76 offen offset:3072 sc1
    s_add_u32 s46, s76, 4096
    buffer_load_dwordx4 a[16:19], v2, s[32:35], s46 offen offset:0 sc1
    buffer_load_dwordx4 a[20:23], v2, s[32:35], s77 offen offset:0 sc1
    s_or_b32 s46, s45, 3
    v_mov_b32 v31, s46
    s_waitcnt vmcnt(6)
    s_mov_b64 exec, 1
    buffer_store_dword v31, v6, s[32:35], 0 offen sc1
    s_mov_b64 exec, -1
    s_barrier
    buffer_load_dwordx4 a[24:27], v2, s[32:35], s77 offen offset:1024 sc1
    buffer_load_dwordx4 a[28:31], v2, s[32:35], s77 offen offset:2048 sc1
    buffer_load_dwordx4 a[32:35], v2, s[32:35], s77 offen offset:3072 sc1
    s_add_u32 s46, s77, 4096
    buffer_load_dwordx4 a[36:39], v2, s[32:35], s46 offen offset:0 sc1
    buffer_load_dwordx4 a[40:43], v2, s[32:35], s78 offen offset:0 sc1
    buffer_load_dwordx4 a[44:47], v2, s[32:35], s78 offen offset:1024 sc1
    buffer_load_dwordx4 a[48:51], v2, s[32:35], s78 offen offset:2048 sc1
    buffer_load_dwordx4 a[52:55], v2, s[32:35], s78 offen offset:3072 sc1
    s_add_u32 s46, s78, 4096
    buffer_load_dwordx4 a[56:59], v2, s[32:35], s46 offen offset:0 sc1
    buffer_load_dwordx4 a[60:63], v2, s[32:35], s79 offen offset:0 sc1
    buffer_load_dwordx4 a[64:67], v2, s[32:35], s79 offen offset:1024 sc1
    buffer_load_dwordx4 a[68:71], v2, s[32:35], s79 offen offset:2048 sc1
    buffer_load_dwordx4 a[72:75], v2, s[32:35], s79 offen offset:3072 sc1
    s_add_u32 s46, s79, 4096
    buffer_load_dwordx4 a[76:79], v2, s[32:35], s46 offen offset:0 sc1
    buffer_load_dwordx4 a[80:83], v2, s[32:35], s80 offen offset:0 sc1
    buffer_load_dwordx4 a[84:87], v2, s[32:35], s80 offen offset:1024 sc1
    buffer_load_dwordx4 a[88:91], v2, s[32:35], s80 offen offset:2048 sc1
    buffer_load_dwordx4 a[92:95], v2, s[32:35], s80 offen offset:3072 sc1
    s_add_u32 s46, s80, 4096
    buffer_load_dwordx4 a[96:99], v2, s[32:35], s46 offen offset:0 sc1
    buffer_load_dwordx4 a[100:103], v2, s[32:35], s81 offen offset:0 sc1
    buffer_load_dwordx4 a[104:107], v2, s[32:35], s81 offen offset:1024 sc1
    buffer_load_dwordx4 a[108:111], v2, s[32:35], s81 offen offset:2048 sc1
    buffer_load_dwordx4 a[112:115], v2, s[32:35], s81 offen offset:3072 sc1
    s_add_u32 s46, s81, 4096
    buffer_load_dwordx4 a[116:119], v2, s[32:35], s46 offen offset:0 sc1
L_join:
    buffer_load_dwordx2 v[8:9], v7, s[32:35], 0 offen sc1
    s_add_u32 s46, s36, 1
    s_and_b32 s46, s46, 3
    s_mul_i32 s47, s46, 35840
    s_sub_u32 s46, s36, s46
    s_sub_u32 s46, s46, 1
    s_sub_u32 s48, s46, 0
    s_and_b32 s48, s48, 7
    s_lshl_b32 s48, s48, 10
    s_add_u32 s48, s48, s47
    v_add_u32 v16, s48, v2
    s_sub_u32 s48, s46, 4
    s_and_b32 s48, s48, 7
    s_lshl_b32 s48, s48, 10
    s_add_u32 s48, s48, s47
    v_add_u32 v17, s48, v2
    s_add_u32 s46, s36, 2
    s_and_b32 s46, s46, 3
    s_mul_i32 s47, s46, 35840
    s_sub_u32 s46, s36, s46
    s_sub_u32 s46, s46, 1
    s_sub_u32 s48, s46, 0
    s_and_b32 s48, s48, 7
    s_lshl_b32 s48, s48, 10
    s_add_u32 s48, s48, s47
    v_add_u32 v18, s48, v2
    s_sub_u32 s48, s46, 4
    s_and_b32 s48, s48, 7
    s_lshl_b32 s48, s48, 10
    s_add_u32 s48, s48, s47
    v_add_u32 v19, s48, v2
    s_add_u32 s46, s36, 3
    s_and_b32 s46, s46, 3
    s_mul_i32 s47, s46, 35840
    s_sub_u32 s46, s36, s46
    s_sub_u32 s46, s46, 1
    s_sub_u32 s48, s46, 0
    s_and_b32 s48, s48, 7
    s_lshl_b32 s48, s48, 10
    s_add_u32 s48, s48, s47
    v_add_u32 v20, s48, v2
    s_sub_u32 s48, s46, 4
    s_and_b32 s48, s48, 7
    s_lshl_b32 s48, s48, 10
    s_add_u32 s48, s48, s47
    v_add_u32 v21, s48, v2
    s_add_u32 s46, s36, 4
    s_and_b32 s46, s46, 3
    s_mul_i32 s47, s46, 35840
    s_sub_u32 s46, s36, s46
    s_sub_u32 s46, s46, 1
    s_sub_u32 s48, s46, 0
    s_and_b32 s48, s48, 7
    s_lshl_b32 s48, s48, 10
    s_add_u32 s48, s48, s47
    v_add_u32 v22, s48, v2
    s_sub_u32 s48, s46, 4
    s_and_b32 s48, s48, 7
    s_lshl_b32 s48, s48, 10
    s_add_u32 s48, s48, s47
    v_add_u32 v23, s48, v2
    s_mul_i32 s46, s37, 35840
    v_add_u32 v13, s46, v2
    v_lshrrev_b32 v12, 4, v1
    v_lshlrev_b32 v12, 3, v12
    s_mul_i32 s71, s42, 160
    v_and_b32 v14, 15, v1
    v_mul_u32_u24 v14, 1280, v14
    v_add_u32 v14, v14, v12
    s_lshl_b32 s46, s41, 6
    s_lshl_b32 s48, s37, 4
    s_add_u32 s46, s46, s48
    s_mul_i32 s46, s46, 1280
    s_add_u32 s58, s46, s71
    s_waitcnt vmcnt(0)
    s_or_b32 s46, s45, 2
    v_xor_b32 v8, s46, v8
    v_xor_b32 v9, s46, v9
    v_or_b32 v8, v8, v9
    v_and_b32 v8, 0xfffffffe, v8
    v_cmp_eq_u32 vcc, 0, v8
    s_nop 1
    s_cmp_eq_u64 vcc, -1
    s_cbranch_scc1 L_ok13
    s_mov_b32 s49, 60000
L_retry14:
    s_sub_u32 s49, s49, 1
    s_cmp_eq_u32 s49, 0
    s_cbranch_scc1 L_ok13
    buffer_load_dwordx2 v[8:9], v7, s[32:35], 0 offen sc1
    s_waitcnt vmcnt(0)
    s_or_b32 s46, s45, 2
    v_xor_b32 v8, s46, v8
    v_xor_b32 v9, s46, v9
    v_or_b32 v8, v8, v9
    v_and_b32 v8, 0xfffffffe, v8
    v_cmp_eq_u32 vcc, 0, v8
    s_nop 1
    s_cmp_eq_u64 vcc, -1
    s_cbranch_scc0 L_retry14
L_ok13:
    s_add_u32 s46, s82, s52
    buffer_load_dwordx4 v[24:27], v2, s[32:35], s46 offen sc1
    s_add_u32 s46, s82, s53
    buffer_load_dwordx4 v[28:31], v2, s[32:35], s46 offen sc1
    s_add_u32 s46, s82, s54
    buffer_load_dwordx4 v[32:35], v2, s[32:35], s46 offen sc1
    s_add_u32 s46, s82, s55
    buffer_load_dwordx4 v[36:39], v2, s[32:35], s46 offen sc1
    s_add_u32 s46, s83, s52
    buffer_load_dwordx4 v[40:43], v2, s[32:35], s46 offen sc1
    s_add_u32 s46, s83, s53
    buffer_load_dwordx4 v[44:47], v2, s[32:35], s46 offen sc1
    s_add_u32 s46, s83, s54
    buffer_load_dwordx4 a[120:123], v2, s[32:35], s46 offen sc1
    s_waitcnt vmcnt(6)
    v_mfma_f32_16x16x32_bf16 v[48:51], a[0:3], v[24:27], 0
    v_mfma_f32_16x16x32_bf16 v[52:55], a[4:7], v[24:27], 0
    v_mfma_f32_16x16x32_bf16 v[56:59], a[8:11], v[24:27], 0
    v_mfma_f32_16x16x32_bf16 v[60:63], a[12:15], v[24:27], 0
    v_mfma_f32_16x16x32_bf16 v[64:67], a[16:19], v[24:27], 0
    s_add_u32 s46, s83, s55
    buffer_load_dwordx4 a[124:127], v2, s[32:35], s46 offen sc1
    s_waitcnt vmcnt(6)
    v_mfma_f32_16x16x32_bf16 v[68:71], a[0:3], v[28:31], 0
    v_mfma_f32_16x16x32_bf16 v[72:75], a[4:7], v[28:31], 0
    v_mfma_f32_16x16x32_bf16 v[76:79], a[8:11], v[28:31], 0
    v_mfma_f32_16x16x32_bf16 v[80:83], a[12:15], v[28:31], 0
    v_mfma_f32_16x16x32_bf16 v[84:87], a[16:19], v[28:31], 0
    s_add_u32 s46, s84, s52
    buffer_load_dwordx4 v[24:27], v2, s[32:35], s46 offen sc1
    s_waitcnt vmcnt(6)
    v_mfma_f32_16x16x32_bf16 v[88:91], a[0:3], v[32:35], 0
    v_mfma_f32_16x16x32_bf16 v[92:95], a[4:7], v[32:35], 0
    v_mfma_f32_16x16x32_bf16 v[96:99], a[8:11], v[32:35], 0
    v_mfma_f32_16x16x32_bf16 v[100:103], a[12:15], v[32:35], 0
    v_mfma_f32_16x16x32_bf16 v[104:107], a[16:19], v[32:35], 0
    s_add_u32 s46, s84, s53
    buffer_load_dwordx4 v[28:31], v2, s[32:35], s46 offen sc1
    s_waitcnt vmcnt(6)
    v_mfma_f32_16x16x32_bf16 v[108:111], a[0:3], v[36:39], 0
    v_mfma_f32_16x16x32_bf16 v[112:115], a[4:7], v[36:39], 0
    v_mfma_f32_16x16x32_bf16 v[116:119], a[8:11], v[36:39], 0
    v_mfma_f32_16x16x32_bf16 v[120:123], a[12:15], v[36:39], 0
    v_mfma_f32_16x16x32_bf16 v[124:127], a[16:19], v[36:39], 0
    s_add_u32 s46, s84, s54
    buffer_load_dwordx4 v[32:35], v2, s[32:35], s46 offen sc1
    s_waitcnt vmcnt(6)
    v_mfma_f32_16x16x32_bf16 v[48:51], a[20:23], v[40:43], v[48:51]
    v_mfma_f32_16x16x32_bf16 v[52:55], a[24:27], v[40:43], v[52:55]
    v_mfma_f32_16x16x32_bf16 v[56:59], a[28:31], v[40:43], v[56:59]
    v_mfma_f32_16x16x32_bf16 v[60:63], a[32:35], v[40:43], v[60:63]
    v_mfma_f32_16x16x32_bf16 v[64:67], a[36:39], v[40:43], v[64:67]
    s_add_u32 s46, s84, s55
    buffer_load_dwordx4 v[36:39], v2, s[32:35], s46 offen sc1
    s_waitcnt vmcnt(6)
    v_mfma_f32_16x16x32_bf16 v[68:71], a[20:23], v[44:47], v[68:71]
    v_mfma_f32_16x16x32_bf16 v[72:75], a[24:27], v[44:47], v[72:75]
    v_mfma_f32_16x16x32_bf16 v[76:79], a[28:31], v[44:47], v[76:79]
    v_mfma_f32_16x16x32_bf16 v[80:83], a[32:35], v[44:47], v[80:83]
    v_mfma_f32_16x16x32_bf16 v[84:87], a[36:39], v[44:47], v[84:87]
    s_add_u32 s46, s85, s52
    buffer_load_dwordx4 v[40:43], v2, s[32:35], s46 offen sc1
    s_waitcnt vmcnt(6)
    v_mfma_f32_16x16x32_bf16 v[88:91], a[20:23], a[120:123], v[88:91]
    v_mfma_f32_16x16x32_bf16 v[92:95], a[24:27], a[120:123], v[92:95]
    v_mfma_f32_16x16x32_bf16 v[96:99], a[28:31], a[120:123], v[96:99]
    v_mfma_f32_16x16x32_bf16 v[100:103], a[32:35], a[120:123], v[100:103]
    v_mfma_f32_16x16x32_bf16 v[104:107], a[36:39], a[120:123], v[104:107]
    s_add_u32 s46, s85, s53
    buffer_load_dwordx4 v[44:47], v2, s[32:35], s46 offen sc1
    s_waitcnt vmcnt(6)
    v_mfma_f32_16x16x32_bf16 v[108:111], a[20:23], a[124:127], v[108:111]
    v_mfma_f32_16x16x32_bf16 v[112:115], a[24:27], a[124:127], v[112:115]
    v_mfma_f32_16x16x32_bf16 v[116:119], a[28:31], a[124:127], v[116:119]
    v_mfma_f32_16x16x32_bf16 v[120:123], a[32:35], a[124:127], v[120:123]
    v_mfma_f32_16x16x32_bf16 v[124:127], a[36:39], a[124:127], v[124:127]
    s_add_u32 s46, s85, s54
    buffer_load_dwordx4 a[120:123], v2, s[32:35], s46 offen sc1
    s_waitcnt vmcnt(6)
    v_mfma_f32_16x16x32_bf16 v[48:51], a[40:43], v[24:27], v[48:51]
    v_mfma_f32_16x16x32_bf16 v[52:55], a[44:47], v[24:27], v[52:55]
    v_mfma_f32_16x16x32_bf16 v[56:59], a[48:51], v[24:27], v[56:59]
    v_mfma_f32_16x16x32_bf16 v[60:63], a[52:55], v[24:27], v[60:63]
    v_mfma_f32_16x16x32_bf16 v[64:67], a[56:59], v[24:27], v[64:67]
    s_add_u32 s46, s85, s55
    buffer_load_dwordx4 a[124:127], v2, s[32:35], s46 offen sc1
    s_waitcnt vmcnt(6)
    v_mfma_f32_16x16x32_bf16 v[68:71], a[40:43], v[28:31], v[68:71]
    v_mfma_f32_16x16x32_bf16 v[72:75], a[44:47], v[28:31], v[72:75]
    v_mfma_f32_16x16x32_bf16 v[76:79], a[48:51], v[28:31], v[76:79]
    v_mfma_f32_16x16x32_bf16 v[80:83], a[52:55], v[28:31], v[80:83]
    v_mfma_f32_16x16x32_bf16 v[84:87], a[56:59], v[28:31], v[84:87]
    s_add_u32 s46, s86, s52
    buffer_load_dwordx4 v[24:27], v2, s[32:35], s46 offen sc1
    s_waitcnt vmcnt(6)
    v_mfma_f32_16x16x32_bf16 v[88:91], a[40:43], v[32:35], v[88:91]
    v_mfma_f32_16x16x32_bf16 v[92:95], a[44:47], v[32:35], v[92:95]
    v_mfma_f32_16x16x32_bf16 v[96:99], a[48:51], v[32:35], v[96:99]
    v_mfma_f32_16x16x32_bf16 v[100:103], a[52:55], v[32:35], v[100:103]
    v_mfma_f32_16x16x32_bf16 v[104:107], a[56:59], v[32:35], v[104:107]
    s_add_u32 s46, s87, s52
    buffer_load_dwordx4 v[28:31], v2, s[32:35], s46 offen sc1
    s_waitcnt vmcnt(6)
    v_mfma_f32_16x16x32_bf16 v[108:111], a[40:43], v[36:39], v[108:111]
    v_mfma_f32_16x16x32_bf16 v[112:115], a[44:47], v[36:39], v[112:115]
    v_mfma_f32_16x16x32_bf16 v[116:119], a[48:51], v[36:39], v[116:119]
    v_mfma_f32_16x16x32_bf16 v[120:123], a[52:55], v[36:39], v[120:123]
    v_mfma_f32_16x16x32_bf16 v[124:127], a[56:59], v[36:39], v[124:127]
    s_add_u32 s46, s86, s53
    buffer_load_dwordx4 v[32:35], v2, s[32:35], s46 offen sc1
    s_waitcnt vmcnt(6)
    v_mfma_f32_16x16x32_bf16 v[48:51], a[60:63], v[40:43], v[48:51]
    v_mfma_f32_16x16x32_bf16 v[52:55], a[64:67], v[40:43], v[52:55]
    v_mfma_f32_16x16x32_bf16 v[56:59], a[68:71], v[40:43], v[56:59]
    v_mfma_f32_16x16x32_bf16 v[60:63], a[72:75], v[40:43], v[60:63]
    v_mfma_f32_16x16x32_bf16 v[64:67], a[76:79], v[40:43], v[64:67]
    s_add_u32 s46, s87, s53
    buffer_load_dwordx4 v[36:39], v2, s[32:35], s46 offen sc1
    s_waitcnt vmcnt(6)
    v_mfma_f32_16x16x32_bf16 v[68:71], a[60:63], v[44:47], v[68:71]
    v_mfma_f32_16x16x32_bf16 v[72:75], a[64:67], v[44:47], v[72:75]
    v_mfma_f32_16x16x32_bf16 v[76:79], a[68:71], v[44:47], v[76:79]
    v_mfma_f32_16x16x32_bf16 v[80:83], a[72:75], v[44:47], v[80:83]
    v_mfma_f32_16x16x32_bf16 v[84:87], a[76:79], v[44:47], v[84:87]
    s_add_u32 s46, s86, s54
    buffer_load_dwordx4 v[40:43], v2, s[32:35], s46 offen sc1
    s_waitcnt vmcnt(6)
    v_mfma_f32_16x16x32_bf16 v[88:91], a[60:63], a[120:123], v[88:91]
    v_mfma_f32_16x16x32_bf16 v[92:95], a[64:67], a[120:123], v[92:95]
    v_mfma_f32_16x16x32_bf16 v[96:99], a[68:71], a[120:123], v[96:99]
    v_mfma_f32_16x16x32_bf16 v[100:103], a[72:75], a[120:123], v[100:103]
    v_mfma_f32_16x16x32_bf16 v[104:107], a[76:79], a[120:123], v[104:107]
    s_add_u32 s46, s87, s54
    buffer_load_dwordx4 v[44:47], v2, s[32:35], s46 offen sc1
    s_waitcnt vmcnt(6)
    v_mfma_f32_16x16x32_bf16 v[108:111], a[60:63], a[124:127], v[108:111]
    v_mfma_f32_16x16x32_bf16 v[112:115], a[64:67], a[124:127], v[112:115]
    v_mfma_f32_16x16x32_bf16 v[116:119], a[68:71], a[124:127], v[116:119]
    v_mfma_f32_16x16x32_bf16 v[120:123], a[72:75], a[124:127], v[120:123]
    v_mfma_f32_16x16x32_bf16 v[124:127], a[76:79], a[124:127], v[124:127]
    s_add_u32 s46, s86, s55
    buffer_load_dwordx4 a[120:123], v2, s[32:35], s46 offen sc1
    s_waitcnt vmcnt(6)
    v_mfma_f32_16x16x32_bf16 v[48:51], a[80:83], v[24:27], v[48:51]
    v_mfma_f32_16x16x32_bf16 v[52:55], a[84:87], v[24:27], v[52:55]
    v_mfma_f32_16x16x32_bf16 v[56:59], a[88:91], v[24:27], v[56:59]
    v_mfma_f32_16x16x32_bf16 v[60:63], a[92:95], v[24:27], v[60:63]
    v_mfma_f32_16x16x32_bf16 v[64:67], a[96:99], v[24:27], v[64:67]
    s_add_u32 s46, s87, s55
    buffer_load_dwordx4 a[124:127], v2, s[32:35], s46 offen sc1
    s_waitcnt vmcnt(6)
    v_mfma_f32_16x16x32_bf16 v[48:51], a[100:103], v[28:31], v[48:51]
    v_mfma_f32_16x16x32_bf16 v[52:55], a[104:107], v[28:31], v[52:55]
    v_mfma_f32_16x16x32_bf16 v[56:59], a[108:111], v[28:31], v[56:59]
    v_mfma_f32_16x16x32_bf16 v[60:63], a[112:115], v[28:31], v[60:63]
    v_mfma_f32_16x16x32_bf16 v[64:67], a[116:119], v[28:31], v[64:67]
    s_waitcnt vmcnt(5)
    v_mfma_f32_16x16x32_bf16 v[68:71], a[80:83], v[32:35], v[68:71]
    v_mfma_f32_16x16x32_bf16 v[72:75], a[84:87], v[32:35], v[72:75]
    v_mfma_f32_16x16x32_bf16 v[76:79], a[88:91], v[32:35], v[76:79]
    v_mfma_f32_16x16x32_bf16 v[80:83], a[92:95], v[32:35], v[80:83]
    v_mfma_f32_16x16x32_bf16 v[84:87], a[96:99], v[32:35], v[84:87]
    ds_write_b128 v16, v[48:51] offset:0
    ds_write_b128 v16, v[52:55] offset:7168
    ds_write_b128 v16, v[56:59] offset:14336
    s_waitcnt vmcnt(4)
    v_mfma_f32_16x16x32_bf16 v[68:71], a[100:103], v[36:39], v[68:71]
    v_mfma_f32_16x16x32_bf16 v[72:75], a[104:107], v[36:39], v[72:75]
    v_mfma_f32_16x16x32_bf16 v[76:79], a[108:111], v[36:39], v[76:79]
    v_mfma_f32_16x16x32_bf16 v[80:83], a[112:115], v[36:39], v[80:83]
    v_mfma_f32_16x16x32_bf16 v[84:87], a[116:119], v[36:39], v[84:87]
    ds_write_b128 v17, v[60:63] offset:21504
    ds_write_b128 v17, v[64:67] offset:28672
    s_waitcnt vmcnt(3)
    v_mfma_f32_16x16x32_bf16 v[88:91], a[80:83], v[40:43], v[88:91]
    v_mfma_f32_16x16x32_bf16 v[92:95], a[84:87], v[40:43], v[92:95]
    v_mfma_f32_16x16x32_bf16 v[96:99], a[88:91], v[40:43], v[96:99]
    v_mfma_f32_16x16x32_bf16 v[100:103], a[92:95], v[40:43], v[100:103]
    v_mfma_f32_16x16x32_bf16 v[104:107], a[96:99], v[40:43], v[104:107]
    ds_write_b128 v18, v[68:71] offset:0
    ds_write_b128 v18, v[72:75] offset:7168
    ds_write_b128 v18, v[76:79] offset:14336
    s_waitcnt vmcnt(2)
    v_mfma_f32_16x16x32_bf16 v[88:91], a[100:103], v[44:47], v[88:91]
    v_mfma_f32_16x16x32_bf16 v[92:95], a[104:107], v[44:47], v[92:95]
    v_mfma_f32_16x16x32_bf16 v[96:99], a[108:111], v[44:47], v[96:99]
    v_mfma_f32_16x16x32_bf16 v[100:103], a[112:115], v[44:47], v[100:103]
    v_mfma_f32_16x16x32_bf16 v[104:107], a[116:119], v[44:47], v[104:107]
    ds_write_b128 v19, v[80:83] offset:21504
    ds_write_b128 v19, v[84:87] offset:28672
    s_waitcnt vmcnt(1)
    v_mfma_f32_16x16x32_bf16 v[108:111], a[80:83], a[120:123], v[108:111]
    v_mfma_f32_16x16x32_bf16 v[112:115], a[84:87], a[120:123], v[112:115]
    v_mfma_f32_16x16x32_bf16 v[116:119], a[88:91], a[120:123], v[116:119]
    v_mfma_f32_16x16x32_bf16 v[120:123], a[92:95], a[120:123], v[120:123]
    v_mfma_f32_16x16x32_bf16 v[124:127], a[96:99], a[120:123], v[124:127]
    ds_write_b128 v20, v[88:91] offset:0
    ds_write_b128 v20, v[92:95] offset:7168
    ds_write_b128 v20, v[96:99] offset:14336
    s_waitcnt vmcnt(0)
    v_mfma_f32_16x16x32_bf16 v[108:111], a[100:103], a[124:127], v[108:111]
    v_mfma_f32_16x16x32_bf16 v[112:115], a[104:107], a[124:127], v[112:115]
    v_mfma_f32_16x16x32_bf16 v[116:119], a[108:111], a[124:127], v[116:119]
    v_mfma_f32_16x16x32_bf16 v[120:123], a[112:115], a[124:127], v[120:123]
    v_mfma_f32_16x16x32_bf16 v[124:127], a[116:119], a[124:127], v[124:127]
    ds_write_b128 v21, v[100:103] offset:21504
    ds_write_b128 v21, v[104:107] offset:28672
    s_cmp_lt_u32 s36, 4
    s_cbranch_scc1 L_tail0
    buffer_load_dwordx2 v[24:25], v12, s[20:23], s71 offen offset:96
    buffer_load_dwordx2 v[26:27], v12, s[20:23], s71 offen offset:128
    s_nop 5
    ds_write_b128 v22, v[108:111] offset:0
    ds_write_b128 v22, v[112:115] offset:7168
    ds_write_b128 v22, v[116:119] offset:14336
    s_waitcnt lgkmcnt(0)
    s_barrier
    ds_read_b128 v[48:51], v13 offset:21504
    ds_read_b128 v[52:55], v13 offset:22528
    ds_read_b128 v[56:59], v13 offset:23552
    ds_read_b128 v[60:63], v13 offset:24576
    ds_read_b128 v[64:67], v13 offset:25600
    ds_read_b128 v[68:71], v13 offset:26624
    ds_read_b128 v[72:75], v13 offset:27648
    ds_read_b128 v[76:79], v13 offset:28672
    ds_read_b128 v[80:83], v13 offset:29696
    ds_read_b128 v[84:87], v13 offset:30720
    ds_read_b128 v[88:91], v13 offset:31744
    ds_read_b128 v[92:95], v13 offset:32768
    ds_read_b128 v[96:99], v13 offset:33792
    ds_read_b128 v[100:103], v13 offset:34816
    s_waitcnt vmcnt(0)
    v_lshlrev_b32 v32, 16, v24
    v_and_b32 v33, 0xffff0000, v24
    v_lshlrev_b32 v34, 16, v25
    v_and_b32 v35, 0xffff0000, v25
    v_pk_add_f32 v[120:121], v[120:121], v[32:33]
    v_pk_add_f32 v[122:123], v[122:123], v[34:35]
    v_lshlrev_b32 v32, 16, v26
    v_and_b32 v33, 0xffff0000, v26
    v_lshlrev_b32 v34, 16, v27
    v_and_b32 v35, 0xffff0000, v27
    v_pk_add_f32 v[124:125], v[124:125], v[32:33]
    v_pk_add_f32 v[126:127], v[126:127], v[34:35]
    s_waitcnt lgkmcnt(13)
    v_pk_add_f32 v[120:121], v[120:121], v[48:49]
    v_pk_add_f32 v[122:123], v[122:123], v[50:51]
    s_waitcnt lgkmcnt(12)
    v_pk_add_f32 v[120:121], v[120:121], v[52:53]
    v_pk_add_f32 v[122:123], v[122:123], v[54:55]
    s_waitcnt lgkmcnt(11)
    v_pk_add_f32 v[120:121], v[120:121], v[56:57]
    v_pk_add_f32 v[122:123], v[122:123], v[58:59]
    s_waitcnt lgkmcnt(10)
    v_pk_add_f32 v[120:121], v[120:121], v[60:61]
    v_pk_add_f32 v[122:123], v[122:123], v[62:63]
    s_waitcnt lgkmcnt(9)
    v_pk_add_f32 v[120:121], v[120:121], v[64:65]
    v_pk_add_f32 v[122:123], v[122:123], v[66:67]
    s_waitcnt lgkmcnt(8)
    v_pk_add_f32 v[120:121], v[120:121], v[68:69]
    v_pk_add_f32 v[122:123], v[122:123], v[70:71]
    s_waitcnt lgkmcnt(7)
    v_pk_add_f32 v[120:121], v[120:121], v[72:73]
    v_pk_add_f32 v[122:123], v[122:123], v[74:75]
    v_cvt_pk_bf16_f32 v120, v120, v121
    v_cvt_pk_bf16_f32 v121, v122, v123
    buffer_store_dwordx2 v[120:121], v14, s[24:27], s58 offen offset:96
    s_waitcnt lgkmcnt(6)
    v_pk_add_f32 v[124:125], v[124:125], v[76:77]
    v_pk_add_f32 v[126:127], v[126:127], v[78:79]
    s_waitcnt lgkmcnt(5)
    v_pk_add_f32 v[124:125], v[124:125], v[80:81]
    v_pk_add_f32 v[126:127], v[126:127], v[82:83]
    s_waitcnt lgkmcnt(4)
    v_pk_add_f32 v[124:125], v[124:125], v[84:85]
    v_pk_add_f32 v[126:127], v[126:127], v[86:87]
    s_waitcnt lgkmcnt(3)
    v_pk_add_f32 v[124:125], v[124:125], v[88:89]
    v_pk_add_f32 v[126:127], v[126:127], v[90:91]
    s_waitcnt lgkmcnt(2)
    v_pk_add_f32 v[124:125], v[124:125], v[92:93]
    v_pk_add_f32 v[126:127], v[126:127], v[94:95]
    s_waitcnt lgkmcnt(1)
    v_pk_add_f32 v[124:125], v[124:125], v[96:97]
    v_pk_add_f32 v[126:127], v[126:127], v[98:99]
    s_waitcnt lgkmcnt(0)
    v_pk_add_f32 v[124:125], v[124:125], v[100:101]
    v_pk_add_f32 v[126:127], v[126:127], v[102:103]
    v_cvt_pk_bf16_f32 v124, v124, v125
    v_cvt_pk_bf16_f32 v125, v126, v127
    buffer_store_dwordx2 v[124:125], v14, s[24:27], s58 offen offset:128
    s_branch L_fin
L_tail0:
    buffer_load_dwordx2 v[24:25], v12, s[20:23], s71 offen offset:0
    buffer_load_dwordx2 v[26:27], v12, s[20:23], s71 offen offset:32
    buffer_load_dwordx2 v[28:29], v12, s[20:23], s71 offen offset:64
    s_nop 5
    ds_write_b128 v23, v[120:123] offset:21504
    ds_write_b128 v23, v[124:127] offset:28672
    s_waitcnt lgkmcnt(0)
    s_barrier
    ds_read_b128 v[48:51], v13 offset:0
    ds_read_b128 v[52:55], v13 offset:1024
    ds_read_b128 v[56:59], v13 offset:2048
    ds_read_b128 v[60:63], v13 offset:3072
    ds_read_b128 v[64:67], v13 offset:4096
    ds_read_b128 v[68:71], v13 offset:5120
    ds_read_b128 v[72:75], v13 offset:6144
    ds_read_b128 v[76:79], v13 offset:7168
    ds_read_b128 v[80:83], v13 offset:8192
    ds_read_b128 v[84:87], v13 offset:9216
    ds_read_b128 v[88:91], v13 offset:10240
    ds_read_b128 v[92:95], v13 offset:11264
    ds_read_b128 v[96:99], v13 offset:12288
    ds_read_b128 v[100:103], v13 offset:13312
    s_waitcnt vmcnt(0)
    v_lshlrev_b32 v32, 16, v24
    v_and_b32 v33, 0xffff0000, v24
    v_lshlrev_b32 v34, 16, v25
    v_and_b32 v35, 0xffff0000, v25
    v_pk_add_f32 v[108:109], v[108:109], v[32:33]
    v_pk_add_f32 v[110:111], v[110:111], v[34:35]
    v_lshlrev_b32 v32, 16, v26
    v_and_b32 v33, 0xffff0000, v26
    v_lshlrev_b32 v34, 16, v27
    v_and_b32 v35, 0xffff0000, v27
    v_pk_add_f32 v[112:113], v[112:113], v[32:33]
    v_pk_add_f32 v[114:115], v[114:115], v[34:35]
    v_lshlrev_b32 v32, 16, v28
    v_and_b32 v33, 0xffff0000, v28
    v_lshlrev_b32 v34, 16, v29
    v_and_b32 v35, 0xffff0000, v29
    v_pk_add_f32 v[116:117], v[116:117], v[32:33]
    v_pk_add_f32 v[118:119], v[118:119], v[34:35]
    s_waitcnt lgkmcnt(13)
    v_pk_add_f32 v[108:109], v[108:109], v[48:49]
    v_pk_add_f32 v[110:111], v[110:111], v[50:51]
    ds_read_b128 v[48:51], v13 offset:14336
    s_waitcnt lgkmcnt(13)
    v_pk_add_f32 v[108:109], v[108:109], v[52:53]
    v_pk_add_f32 v[110:111], v[110:111], v[54:55]
    ds_read_b128 v[52:55], v13 offset:15360
    s_waitcnt lgkmcnt(13)
    v_pk_add_f32 v[108:109], v[108:109], v[56:57]
    v_pk_add_f32 v[110:111], v[110:111], v[58:59]
    ds_read_b128 v[56:59], v13 offset:16384
    s_waitcnt lgkmcnt(13)
    v_pk_add_f32 v[108:109], v[108:109], v[60:61]
    v_pk_add_f32 v[110:111], v[110:111], v[62:63]
    ds_read_b128 v[60:63], v13 offset:17408
    s_waitcnt lgkmcnt(13)
    v_pk_add_f32 v[108:109], v[108:109], v[64:65]
    v_pk_add_f32 v[110:111], v[110:111], v[66:67]
    ds_read_b128 v[64:67], v13 offset:18432
    s_waitcnt lgkmcnt(13)
    v_pk_add_f32 v[108:109], v[108:109], v[68:69]
    v_pk_add_f32 v[110:111], v[110:111], v[70:71]
    ds_read_b128 v[68:71], v13 offset:19456
    s_waitcnt lgkmcnt(13)
    v_pk_add_f32 v[108:109], v[108:109], v[72:73]
    v_pk_add_f32 v[110:111], v[110:111], v[74:75]
    ds_read_b128 v[72:75], v13 offset:20480
    v_cvt_pk_bf16_f32 v108, v108, v109
    v_cvt_pk_bf16_f32 v109, v110, v111
    buffer_store_dwordx2 v[108:109], v14, s[24:27], s58 offen offset:0
    s_waitcnt lgkmcnt(13)
    v_pk_add_f32 v[112:113], v[112:113], v[76:77]
    v_pk_add_f32 v[114:115], v[114:115], v[78:79]
    s_waitcnt lgkmcnt(12)
    v_pk_add_f32 v[112:113], v[112:113], v[80:81]
    v_pk_add_f32 v[114:115], v[114:115], v[82:83]
    s_waitcnt lgkmcnt(11)
    v_pk_add_f32 v[112:113], v[112:113], v[84:85]
    v_pk_add_f32 v[114:115], v[114:115], v[86:87]
    s_waitcnt lgkmcnt(10)
    v_pk_add_f32 v[112:113], v[112:113], v[88:89]
    v_pk_add_f32 v[114:115], v[114:115], v[90:91]
    s_waitcnt lgkmcnt(9)
    v_pk_add_f32 v[112:113], v[112:113], v[92:93]
    v_pk_add_f32 v[114:115], v[114:115], v[94:95]
    s_waitcnt lgkmcnt(8)
    v_pk_add_f32 v[112:113], v[112:113], v[96:97]
    v_pk_add_f32 v[114:115], v[114:115], v[98:99]
    s_waitcnt lgkmcnt(7)
    v_pk_add_f32 v[112:113], v[112:113], v[100:101]
    v_pk_add_f32 v[114:115], v[114:115], v[102:103]
    v_cvt_pk_bf16_f32 v112, v112, v113
    v_cvt_pk_bf16_f32 v113, v114, v115
    buffer_store_dwordx2 v[112:113], v14, s[24:27], s58 offen offset:32
    s_waitcnt lgkmcnt(6)
    v_pk_add_f32 v[116:117], v[116:117], v[48:49]
    v_pk_add_f32 v[118:119], v[118:119], v[50:51]
    s_waitcnt lgkmcnt(5)
    v_pk_add_f32 v[116:117], v[116:117], v[52:53]
    v_pk_add_f32 v[118:119], v[118:119], v[54:55]
    s_waitcnt lgkmcnt(4)
    v_pk_add_f32 v[116:117], v[116:117], v[56:57]
    v_pk_add_f32 v[118:119], v[118:119], v[58:59]
    s_waitcnt lgkmcnt(3)
    v_pk_add_f32 v[116:117], v[116:117], v[60:61]
    v_pk_add_f32 v[118:119], v[118:119], v[62:63]
    s_waitcnt lgkmcnt(2)
    v_pk_add_f32 v[116:117], v[116:117], v[64:65]
    v_pk_add_f32 v[118:119], v[118:119], v[66:67]
    s_waitcnt lgkmcnt(1)
    v_pk_add_f32 v[116:117], v[116:117], v[68:69]
    v_pk_add_f32 v[118:119], v[118:119], v[70:71]
    s_waitcnt lgkmcnt(0)
    v_pk_add_f32 v[116:117], v[116:117], v[72:73]
    v_pk_add_f32 v[118:119], v[118:119], v[74:75]
    v_cvt_pk_bf16_f32 v116, v116, v117
    v_cvt_pk_bf16_f32 v117, v118, v119
    buffer_store_dwordx2 v[116:117], v14, s[24:27], s58 offen offset:64
L_fin:
L_end:
    s_endpgm
.section .rodata,"a"
.p2align 6
.amdhsa_kernel standalone__mixer_channel_mlp__prompt_kernel
  .amdhsa_next_free_vgpr 256
  .amdhsa_next_free_sgpr 102
  .amdhsa_accum_offset 128
  .amdhsa_group_segment_fixed_size 0
  .amdhsa_kernarg_size 64
  .amdhsa_user_sgpr_count 2
  .amdhsa_user_sgpr_kernarg_segment_ptr 1
  .amdhsa_system_sgpr_workgroup_id_x 1
.end_amdhsa_kernel
```
